```python
import torch

def _softmax(x, axis=-1):
    return torch.softmax(x, dim=axis)
def _gelu(x):
    return torch.nn.functional.gelu(x, approximate="tanh")
def _silu(x):
    return torch.nn.functional.silu(x)
def _sigmoid(x):
    return torch.sigmoid(x)
def _layernorm(x, axis=-1, eps=1e-5):
    m = x.mean(dim=axis, keepdim=True)
    v = x.var(dim=axis, keepdim=True, unbiased=False)
    return (x - m) / torch.sqrt(v + eps)
def _scatter_add(tgt, idx, src, axis=0):
    return tgt.clone().index_add_(axis, idx, src)
def _segment_sum(src, seg, n):
    out = torch.zeros((n,) + src.shape[1:], dtype=src.dtype)
    return out.index_add_(0, seg, src)
def _pad(x, pw):
    flat = tuple(v for pair in reversed(pw) for v in pair)
    return torch.nn.functional.pad(x, flat)

kernel_name = 'standalone__gqa_softmax__sampling'

def setup_inputs():

    _w = (lambda a: (lambda t: t.to(torch.bfloat16) if t.is_floating_point() else t)(torch.as_tensor(a)))
    B, Hq, Hkv, Sq, Sk, D = 8, 32, 8, 32, 2048, 128
    return {
        "q": _w((lambda *s: torch.randn(*s, dtype=torch.bfloat16) * 0.8)(B, Hq, Sq, D)),
        "k": _w((lambda *s: torch.randn(*s, dtype=torch.bfloat16) * 0.8)(B, Hkv, Sk, D)),
        "v": _w((lambda *s: torch.randn(*s, dtype=torch.bfloat16) * 0.05)(B, Hkv, Sk, D)),
    }

def reference(q, k, v):
    B, Hq, Sq, D = q.shape
    Hkv = k.shape[1]
    rep = Hq // Hkv
    k = (lambda x, n, axis: torch.repeat_interleave(x, n, dim=axis))(k, rep, axis=1)
    v = (lambda x, n, axis: torch.repeat_interleave(x, n, dim=axis))(v, rep, axis=1)
    scale = D ** -0.5
    scores = torch.einsum("bhqd,bhkd->bhqk", q, k) * scale
    p = _softmax(scores, axis=-1)
    return torch.einsum("bhqk,bhkd->bhqd", p, v)
```

```asm
; @launch grid=(256,1,1) block=(512,1,1) lds=135232
.amdgcn_target "amdgcn-amd-amdhsa--gfx950"
.text
.globl standalone__gqa_softmax__sampling_kernel
.p2align 8
.type standalone__gqa_softmax__sampling_kernel,@function
standalone__gqa_softmax__sampling_kernel:
  s_cmp_ge_u32 s2, 256
  s_cbranch_scc1 L_done
  s_load_dwordx4 s[4:7], s[0:1], 0
  s_load_dwordx2 s[8:9], s[0:1], 16
  s_load_dwordx4 s[12:15], s[0:1], 24
  s_load_dwordx2 s[10:11], s[0:1], 40
  v_lshrrev_b32 v1, 6, v0
  v_and_b32 v2, 63, v0
  v_readfirstlane_b32 s20, v1
  s_nop 3
  s_and_b32 s21, s20, 3
  s_lshr_b32 s22, s20, 2
  s_lshr_b32 s58, s2, 2
  s_and_b32 s59, s2, 3
  v_and_b32 v3, 31, v2
  v_lshrrev_b32 v4, 5, v2
  v_and_b32 v5, 15, v2
  v_lshrrev_b32 v6, 4, v2
  s_lshl_b32 s36, s20, 3
  v_add_u32 v8, s36, v6
  v_and_b32 v9, 15, v8
  v_xor_b32 v9, v9, v5
  v_lshlrev_b32 v236, 8, v8
  v_lshl_add_u32 v236, v9, 4, v236
  v_add_u32 v10, 4, v8
  v_and_b32 v9, 15, v10
  v_xor_b32 v9, v9, v5
  v_lshlrev_b32 v237, 8, v10
  v_lshl_add_u32 v237, v9, 4, v237
  v_subrev_u32 v237, 1024, v237
  v_lshlrev_b32 v9, 2, v6
  v_xor_b32 v9, v9, v5
  v_lshlrev_b32 v238, 8, v8
  v_lshl_add_u32 v238, v9, 4, v238
  s_lshl_b32 s37, s20, 11
  s_lshl_b32 s23, s2, 17
  s_waitcnt lgkmcnt(0)
  s_lshr_b32 s24, s58, 2
  s_lshl_b32 s24, s24, 2
  s_add_u32 s24, s24, 192
  s_and_b32 s65, s58, 3
  s_lshl_b32 s65, s65, 3
  s_add_u32 s60, s14, s24
  s_addc_u32 s61, s15, 0
  s_mov_b32 s62, 4
  s_mov_b32 s63, 0x00020000
  v_lshlrev_b32 v15, 2, v2
  s_cmp_lg_u32 s20, 0
  s_cbranch_scc1 L_noarrive
  s_lshl_b32 s24, s2, 7
  s_add_u32 s24, s24, 17825792
  s_add_u32 s16, s10, s24
  s_addc_u32 s17, s11, 0
  s_mov_b32 s18, 4
  s_mov_b32 s19, 0x00020000
  v_mov_b32 v14, 0
  buffer_store_dword v14, v15, s[16:19], 0 offen sc1
L_noarrive:
  s_add_u32 s28, s6, s23
  s_addc_u32 s29, s7, 0
  s_mov_b32 s30, 131072
  s_mov_b32 s31, 0x00020000
  s_add_u32 s38, s37, 0
  s_mov_b32 m0, s38
  s_mov_b32 s39, 0
  buffer_load_dwordx4 v236, s[28:31], s39 offen nt lds
  buffer_load_dwordx4 v237, s[28:31], s39 offen offset:1024 nt lds
  s_add_u32 s32, s8, s23
  s_addc_u32 s33, s9, 0
  s_mov_b32 s34, 131072
  s_mov_b32 s35, 0x00020000
  s_lshl_b32 s23, s58, 2
  s_add_u32 s23, s23, s21
  s_lshl_b32 s23, s23, 13
  s_add_u32 s24, s4, s23
  s_addc_u32 s25, s5, 0
  s_mov_b32 s26, 8192
  s_mov_b32 s27, 0x00020000
  v_lshlrev_b32 v7, 8, v3
  v_lshl_add_u32 v7, v4, 4, v7
  buffer_load_dwordx4 v[16:19], v7, s[24:27], 0 offen offset:0
  buffer_load_dwordx4 v[20:23], v7, s[24:27], 0 offen offset:32
  buffer_load_dwordx4 v[24:27], v7, s[24:27], 0 offen offset:64
  buffer_load_dwordx4 v[28:31], v7, s[24:27], 0 offen offset:96
  buffer_load_dwordx4 v[32:35], v7, s[24:27], 0 offen offset:128
  buffer_load_dwordx4 v[36:39], v7, s[24:27], 0 offen offset:160
  buffer_load_dwordx4 v[40:43], v7, s[24:27], 0 offen offset:192
  buffer_load_dwordx4 v[44:47], v7, s[24:27], 0 offen offset:224
  s_add_u32 s38, s37, 16384
  s_mov_b32 m0, s38
  s_mov_b32 s39, 16384
  buffer_load_dwordx4 v236, s[28:31], s39 offen nt lds
  buffer_load_dwordx4 v237, s[28:31], s39 offen offset:1024 nt lds
  s_add_u32 s38, s37, 65536
  s_mov_b32 m0, s38
  s_mov_b32 s39, 0
  buffer_load_dwordx4 v238, s[32:35], s39 offen nt lds
  buffer_load_dwordx4 v238, s[32:35], s39 offen offset:1024 nt lds
  s_add_u32 s38, s37, 32768
  s_mov_b32 m0, s38
  s_mov_b32 s39, 32768
  buffer_load_dwordx4 v236, s[28:31], s39 offen nt lds
  buffer_load_dwordx4 v237, s[28:31], s39 offen offset:1024 nt lds
  v_lshlrev_b32 v8, 8, v3
  v_add_u32 v9, 0, v4
  v_xor_b32 v9, v9, v5
  v_lshl_add_u32 v224, v9, 4, v8
  v_add_u32 v9, 2, v4
  v_xor_b32 v9, v9, v5
  v_lshl_add_u32 v225, v9, 4, v8
  v_add_u32 v9, 4, v4
  v_xor_b32 v9, v9, v5
  v_lshl_add_u32 v226, v9, 4, v8
  v_add_u32 v9, 6, v4
  v_xor_b32 v9, v9, v5
  v_lshl_add_u32 v227, v9, 4, v8
  v_add_u32 v9, 8, v4
  v_xor_b32 v9, v9, v5
  v_lshl_add_u32 v228, v9, 4, v8
  v_add_u32 v9, 10, v4
  v_xor_b32 v9, v9, v5
  v_lshl_add_u32 v229, v9, 4, v8
  v_add_u32 v9, 12, v4
  v_xor_b32 v9, v9, v5
  v_lshl_add_u32 v230, v9, 4, v8
  v_add_u32 v9, 14, v4
  v_xor_b32 v9, v9, v5
  v_lshl_add_u32 v231, v9, 4, v8
  v_lshrrev_b32 v9, 2, v5
  v_lshl_add_u32 v10, v4, 2, v9
  v_lshlrev_b32 v10, 8, v10
  v_add_u32 v10, 0x10000, v10
  v_and_b32 v11, 1, v6
  v_lshl_add_u32 v10, v11, 5, v10
  v_and_b32 v11, 3, v5
  v_lshl_add_u32 v10, v11, 3, v10
  v_xor_b32 v11, 0, v9
  v_lshl_add_u32 v232, v11, 6, v10
  v_xor_b32 v11, 1, v9
  v_lshl_add_u32 v233, v11, 6, v10
  v_xor_b32 v11, 2, v9
  v_lshl_add_u32 v234, v11, 6, v10
  v_xor_b32 v11, 3, v9
  v_lshl_add_u32 v235, v11, 6, v10
  v_mov_b32 v160, 0
  v_mov_b32 v161, 0
  v_mov_b32 v162, 0
  v_mov_b32 v163, 0
  v_mov_b32 v164, 0
  v_mov_b32 v165, 0
  v_mov_b32 v166, 0
  v_mov_b32 v167, 0
  v_mov_b32 v168, 0
  v_mov_b32 v169, 0
  v_mov_b32 v170, 0
  v_mov_b32 v171, 0
  v_mov_b32 v172, 0
  v_mov_b32 v173, 0
  v_mov_b32 v174, 0
  v_mov_b32 v175, 0
  v_mov_b32 v176, 0
  v_mov_b32 v177, 0
  v_mov_b32 v178, 0
  v_mov_b32 v179, 0
  v_mov_b32 v180, 0
  v_mov_b32 v181, 0
  v_mov_b32 v182, 0
  v_mov_b32 v183, 0
  v_mov_b32 v184, 0
  v_mov_b32 v185, 0
  v_mov_b32 v186, 0
  v_mov_b32 v187, 0
  v_mov_b32 v188, 0
  v_mov_b32 v189, 0
  v_mov_b32 v190, 0
  v_mov_b32 v191, 0
  v_mov_b32 v192, 0
  v_mov_b32 v193, 0
  v_mov_b32 v194, 0
  v_mov_b32 v195, 0
  v_mov_b32 v196, 0
  v_mov_b32 v197, 0
  v_mov_b32 v198, 0
  v_mov_b32 v199, 0
  v_mov_b32 v200, 0
  v_mov_b32 v201, 0
  v_mov_b32 v202, 0
  v_mov_b32 v203, 0
  v_mov_b32 v204, 0
  v_mov_b32 v205, 0
  v_mov_b32 v206, 0
  v_mov_b32 v207, 0
  v_mov_b32 v208, 0
  v_mov_b32 v209, 0
  v_mov_b32 v210, 0
  v_mov_b32 v211, 0
  v_mov_b32 v212, 0
  v_mov_b32 v213, 0
  v_mov_b32 v214, 0
  v_mov_b32 v215, 0
  v_mov_b32 v216, 0
  v_mov_b32 v217, 0
  v_mov_b32 v218, 0
  v_mov_b32 v219, 0
  v_mov_b32 v220, 0
  v_mov_b32 v221, 0
  v_mov_b32 v222, 0
  v_mov_b32 v223, 0
  v_mov_b32 v239, 0xff800000
  v_mov_b32 v240, 0
  s_mov_b32 s41, 0x3e0293ee
  s_mov_b32 s57, 0x41000000
  s_cmp_ge_u32 s22, 1
  s_cbranch_scc1 L_groupB
  s_waitcnt vmcnt(6)
  s_cmp_lg_u32 s20, 0
  s_cbranch_scc1 L_noarr2
  s_lshl_b32 s24, 1, s65
  v_mov_b32 v14, s24
  buffer_atomic_add v14, v15, s[60:63], 0 offen sc1
L_noarr2:
  s_barrier
  s_add_u32 s38, s37, 49152
  s_mov_b32 m0, s38
  s_mov_b32 s39, 49152
  buffer_load_dwordx4 v236, s[28:31], s39 offen nt lds
  buffer_load_dwordx4 v237, s[28:31], s39 offen offset:1024 nt lds
  s_add_u32 s38, s37, 81920
  s_mov_b32 m0, s38
  s_mov_b32 s39, 16384
  buffer_load_dwordx4 v238, s[32:35], s39 offen nt lds
  buffer_load_dwordx4 v238, s[32:35], s39 offen offset:1024 nt lds
  s_setprio 1
  ds_read_b128 v[48:51], v224 offset:0
  ds_read_b128 v[52:55], v225 offset:0
  ds_read_b128 v[56:59], v226 offset:0
  ds_read_b128 v[60:63], v227 offset:0
  ds_read_b128 v[64:67], v228 offset:0
  ds_read_b128 v[68:71], v229 offset:0
  ds_read_b128 v[72:75], v230 offset:0
  ds_read_b128 v[76:79], v231 offset:0
  s_waitcnt lgkmcnt(7)
  v_mfma_f32_32x32x16_bf16 v[112:127], v[48:51], v[16:19], 0
  ds_read_b128 v[48:51], v224 offset:8192
  s_waitcnt lgkmcnt(7)
  v_mfma_f32_32x32x16_bf16 v[112:127], v[52:55], v[20:23], v[112:127]
  ds_read_b128 v[52:55], v225 offset:8192
  s_waitcnt lgkmcnt(7)
  v_mfma_f32_32x32x16_bf16 v[112:127], v[56:59], v[24:27], v[112:127]
  ds_read_b128 v[56:59], v226 offset:8192
  s_waitcnt lgkmcnt(7)
  v_mfma_f32_32x32x16_bf16 v[112:127], v[60:63], v[28:31], v[112:127]
  ds_read_b128 v[60:63], v227 offset:8192
  s_waitcnt lgkmcnt(7)
  v_mfma_f32_32x32x16_bf16 v[112:127], v[64:67], v[32:35], v[112:127]
  ds_read_b128 v[64:67], v228 offset:8192
  s_waitcnt lgkmcnt(7)
  v_mfma_f32_32x32x16_bf16 v[112:127], v[68:71], v[36:39], v[112:127]
  ds_read_b128 v[68:71], v229 offset:8192
  s_waitcnt lgkmcnt(7)
  v_mfma_f32_32x32x16_bf16 v[112:127], v[72:75], v[40:43], v[112:127]
  ds_read_b128 v[72:75], v230 offset:8192
  s_waitcnt lgkmcnt(7)
  v_mfma_f32_32x32x16_bf16 v[112:127], v[76:79], v[44:47], v[112:127]
  ds_read_b128 v[76:79], v231 offset:8192
  s_waitcnt lgkmcnt(7)
  v_mfma_f32_32x32x16_bf16 v[128:143], v[48:51], v[16:19], 0
  s_waitcnt lgkmcnt(6)
  v_mfma_f32_32x32x16_bf16 v[128:143], v[52:55], v[20:23], v[128:143]
  s_waitcnt lgkmcnt(5)
  v_mfma_f32_32x32x16_bf16 v[128:143], v[56:59], v[24:27], v[128:143]
  s_waitcnt lgkmcnt(4)
  v_mfma_f32_32x32x16_bf16 v[128:143], v[60:63], v[28:31], v[128:143]
  s_waitcnt lgkmcnt(3)
  v_mfma_f32_32x32x16_bf16 v[128:143], v[64:67], v[32:35], v[128:143]
  s_waitcnt lgkmcnt(2)
  v_mfma_f32_32x32x16_bf16 v[128:143], v[68:71], v[36:39], v[128:143]
  s_waitcnt lgkmcnt(1)
  v_mfma_f32_32x32x16_bf16 v[128:143], v[72:75], v[40:43], v[128:143]
  s_waitcnt lgkmcnt(0)
  v_mfma_f32_32x32x16_bf16 v[128:143], v[76:79], v[44:47], v[128:143]
  s_setprio 0
  s_waitcnt vmcnt(8)
  s_barrier
  s_add_u32 s38, s37, 0
  s_mov_b32 m0, s38
  s_mov_b32 s39, 65536
  buffer_load_dwordx4 v236, s[28:31], s39 offen nt lds
  buffer_load_dwordx4 v237, s[28:31], s39 offen offset:1024 nt lds
  s_add_u32 s38, s37, 98304
  s_mov_b32 m0, s38
  s_mov_b32 s39, 32768
  buffer_load_dwordx4 v238, s[32:35], s39 offen nt lds
  buffer_load_dwordx4 v238, s[32:35], s39 offen offset:1024 nt lds
  v_max3_f32 v241, v112, v113, v114
  v_max3_f32 v242, v115, v116, v117
  v_max3_f32 v243, v118, v119, v120
  v_max3_f32 v244, v121, v122, v123
  v_max3_f32 v245, v124, v125, v126
  v_max3_f32 v241, v241, v242, v127
  v_max3_f32 v243, v243, v244, v245
  v_max3_f32 v242, v128, v129, v130
  v_max3_f32 v244, v131, v132, v133
  v_max3_f32 v245, v134, v135, v136
  v_max3_f32 v246, v137, v138, v139
  v_max3_f32 v247, v140, v141, v142
  v_max3_f32 v241, v241, v243, v143
  v_max3_f32 v242, v242, v244, v245
  v_max3_f32 v241, v241, v246, v247
  v_max_f32 v241, v241, v242
  v_mov_b32 v242, v241
  v_add_f32 v243, s57, v239
  s_nop 0
  v_permlane32_swap_b32 v241, v242
  v_max_f32 v241, v241, v242
  v_mul_f32 v241, s41, v241
  v_cmp_gt_f32 vcc, v241, v243
  s_nop 1
  s_cbranch_vccz L_skip_a0
  v_max_f32 v241, v239, v241
  v_sub_f32 v242, v239, v241
  v_exp_f32 v242, v242
  v_mov_b32 v239, v241
  v_mul_f32 v160, v242, v160
  v_mul_f32 v161, v242, v161
  v_mul_f32 v162, v242, v162
  v_mul_f32 v163, v242, v163
  v_mul_f32 v164, v242, v164
  v_mul_f32 v165, v242, v165
  v_mul_f32 v166, v242, v166
  v_mul_f32 v167, v242, v167
  v_mul_f32 v168, v242, v168
  v_mul_f32 v169, v242, v169
  v_mul_f32 v170, v242, v170
  v_mul_f32 v171, v242, v171
  v_mul_f32 v172, v242, v172
  v_mul_f32 v173, v242, v173
  v_mul_f32 v174, v242, v174
  v_mul_f32 v175, v242, v175
  v_mul_f32 v176, v242, v176
  v_mul_f32 v177, v242, v177
  v_mul_f32 v178, v242, v178
  v_mul_f32 v179, v242, v179
  v_mul_f32 v180, v242, v180
  v_mul_f32 v181, v242, v181
  v_mul_f32 v182, v242, v182
  v_mul_f32 v183, v242, v183
  v_mul_f32 v184, v242, v184
  v_mul_f32 v185, v242, v185
  v_mul_f32 v186, v242, v186
  v_mul_f32 v187, v242, v187
  v_mul_f32 v188, v242, v188
  v_mul_f32 v189, v242, v189
  v_mul_f32 v190, v242, v190
  v_mul_f32 v191, v242, v191
  v_mul_f32 v192, v242, v192
  v_mul_f32 v193, v242, v193
  v_mul_f32 v194, v242, v194
  v_mul_f32 v195, v242, v195
  v_mul_f32 v196, v242, v196
  v_mul_f32 v197, v242, v197
  v_mul_f32 v198, v242, v198
  v_mul_f32 v199, v242, v199
  v_mul_f32 v200, v242, v200
  v_mul_f32 v201, v242, v201
  v_mul_f32 v202, v242, v202
  v_mul_f32 v203, v242, v203
  v_mul_f32 v204, v242, v204
  v_mul_f32 v205, v242, v205
  v_mul_f32 v206, v242, v206
  v_mul_f32 v207, v242, v207
  v_mul_f32 v208, v242, v208
  v_mul_f32 v209, v242, v209
  v_mul_f32 v210, v242, v210
  v_mul_f32 v211, v242, v211
  v_mul_f32 v212, v242, v212
  v_mul_f32 v213, v242, v213
  v_mul_f32 v214, v242, v214
  v_mul_f32 v215, v242, v215
  v_mul_f32 v216, v242, v216
  v_mul_f32 v217, v242, v217
  v_mul_f32 v218, v242, v218
  v_mul_f32 v219, v242, v219
  v_mul_f32 v220, v242, v220
  v_mul_f32 v221, v242, v221
  v_mul_f32 v222, v242, v222
  v_mul_f32 v223, v242, v223
  v_mul_f32 v240, v242, v240
L_skip_a0:
  v_fma_f32 v112, v112, s41, -v239
  v_fma_f32 v113, v113, s41, -v239
  v_fma_f32 v114, v114, s41, -v239
  v_fma_f32 v115, v115, s41, -v239
  v_fma_f32 v116, v116, s41, -v239
  v_fma_f32 v117, v117, s41, -v239
  v_fma_f32 v118, v118, s41, -v239
  v_fma_f32 v119, v119, s41, -v239
  v_fma_f32 v120, v120, s41, -v239
  v_fma_f32 v121, v121, s41, -v239
  v_fma_f32 v122, v122, s41, -v239
  v_fma_f32 v123, v123, s41, -v239
  v_fma_f32 v124, v124, s41, -v239
  v_fma_f32 v125, v125, s41, -v239
  v_fma_f32 v126, v126, s41, -v239
  v_fma_f32 v127, v127, s41, -v239
  v_exp_f32 v112, v112
  v_exp_f32 v113, v113
  v_exp_f32 v114, v114
  v_exp_f32 v115, v115
  v_exp_f32 v116, v116
  v_exp_f32 v117, v117
  v_exp_f32 v118, v118
  v_exp_f32 v119, v119
  v_exp_f32 v120, v120
  v_exp_f32 v121, v121
  v_exp_f32 v122, v122
  v_exp_f32 v123, v123
  v_exp_f32 v124, v124
  v_exp_f32 v125, v125
  v_exp_f32 v126, v126
  v_exp_f32 v127, v127
  v_fma_f32 v128, v128, s41, -v239
  v_fma_f32 v129, v129, s41, -v239
  v_fma_f32 v130, v130, s41, -v239
  v_fma_f32 v131, v131, s41, -v239
  v_fma_f32 v132, v132, s41, -v239
  v_fma_f32 v133, v133, s41, -v239
  v_fma_f32 v134, v134, s41, -v239
  v_fma_f32 v135, v135, s41, -v239
  v_fma_f32 v136, v136, s41, -v239
  v_fma_f32 v137, v137, s41, -v239
  v_fma_f32 v138, v138, s41, -v239
  v_fma_f32 v139, v139, s41, -v239
  v_fma_f32 v140, v140, s41, -v239
  v_fma_f32 v141, v141, s41, -v239
  v_fma_f32 v142, v142, s41, -v239
  v_fma_f32 v143, v143, s41, -v239
  v_exp_f32 v128, v128
  v_exp_f32 v129, v129
  v_add_f32 v241, v112, v113
  v_cvt_pk_bf16_f32 v144, v112, v113
  v_add_f32 v240, v240, v241
  v_exp_f32 v130, v130
  v_exp_f32 v131, v131
  v_add_f32 v243, v114, v115
  v_cvt_pk_bf16_f32 v145, v114, v115
  v_add_f32 v240, v240, v243
  v_exp_f32 v132, v132
  v_exp_f32 v133, v133
  v_add_f32 v241, v116, v117
  v_cvt_pk_bf16_f32 v146, v116, v117
  v_add_f32 v240, v240, v241
  v_exp_f32 v134, v134
  v_exp_f32 v135, v135
  v_add_f32 v243, v118, v119
  v_cvt_pk_bf16_f32 v147, v118, v119
  v_add_f32 v240, v240, v243
  v_exp_f32 v136, v136
  v_exp_f32 v137, v137
  v_add_f32 v241, v120, v121
  v_cvt_pk_bf16_f32 v148, v120, v121
  v_add_f32 v240, v240, v241
  v_exp_f32 v138, v138
  v_exp_f32 v139, v139
  v_add_f32 v243, v122, v123
  v_cvt_pk_bf16_f32 v149, v122, v123
  v_add_f32 v240, v240, v243
  v_exp_f32 v140, v140
  v_exp_f32 v141, v141
  v_add_f32 v241, v124, v125
  v_cvt_pk_bf16_f32 v150, v124, v125
  v_add_f32 v240, v240, v241
  v_exp_f32 v142, v142
  v_exp_f32 v143, v143
  v_add_f32 v243, v126, v127
  v_cvt_pk_bf16_f32 v151, v126, v127
  v_add_f32 v240, v240, v243
  v_add_f32 v241, v128, v129
  v_cvt_pk_bf16_f32 v152, v128, v129
  v_add_f32 v240, v240, v241
  v_add_f32 v243, v130, v131
  v_cvt_pk_bf16_f32 v153, v130, v131
  v_add_f32 v240, v240, v243
  v_add_f32 v241, v132, v133
  v_cvt_pk_bf16_f32 v154, v132, v133
  v_add_f32 v240, v240, v241
  v_add_f32 v243, v134, v135
  v_cvt_pk_bf16_f32 v155, v134, v135
  v_add_f32 v240, v240, v243
  v_add_f32 v241, v136, v137
  v_cvt_pk_bf16_f32 v156, v136, v137
  v_add_f32 v240, v240, v241
  v_add_f32 v243, v138, v139
  v_cvt_pk_bf16_f32 v157, v138, v139
  v_add_f32 v240, v240, v243
  v_add_f32 v241, v140, v141
  v_cvt_pk_bf16_f32 v158, v140, v141
  v_add_f32 v240, v240, v241
  v_add_f32 v243, v142, v143
  v_cvt_pk_bf16_f32 v159, v142, v143
  v_add_f32 v240, v240, v243
  s_waitcnt vmcnt(8)
  s_barrier
  s_add_u32 s38, s37, 16384
  s_mov_b32 m0, s38
  s_mov_b32 s39, 81920
  buffer_load_dwordx4 v236, s[28:31], s39 offen nt lds
  buffer_load_dwordx4 v237, s[28:31], s39 offen offset:1024 nt lds
  s_add_u32 s38, s37, 114688
  s_mov_b32 m0, s38
  s_mov_b32 s39, 49152
  buffer_load_dwordx4 v238, s[32:35], s39 offen nt lds
  buffer_load_dwordx4 v238, s[32:35], s39 offen offset:1024 nt lds
  s_setprio 1
  ds_read_b128 v[48:51], v224 offset:32768
  ds_read_b128 v[52:55], v225 offset:32768
  ds_read_b128 v[56:59], v226 offset:32768
  ds_read_b128 v[60:63], v227 offset:32768
  ds_read_b128 v[64:67], v228 offset:32768
  ds_read_b128 v[68:71], v229 offset:32768
  ds_read_b128 v[72:75], v230 offset:32768
  ds_read_b128 v[76:79], v231 offset:32768
  s_waitcnt lgkmcnt(7)
  v_mfma_f32_32x32x16_bf16 v[112:127], v[48:51], v[16:19], 0
  ds_read_b128 v[48:51], v224 offset:40960
  s_waitcnt lgkmcnt(7)
  v_mfma_f32_32x32x16_bf16 v[112:127], v[52:55], v[20:23], v[112:127]
  ds_read_b128 v[52:55], v225 offset:40960
  s_waitcnt lgkmcnt(7)
  v_mfma_f32_32x32x16_bf16 v[112:127], v[56:59], v[24:27], v[112:127]
  ds_read_b128 v[56:59], v226 offset:40960
  s_waitcnt lgkmcnt(7)
  v_mfma_f32_32x32x16_bf16 v[112:127], v[60:63], v[28:31], v[112:127]
  ds_read_b128 v[60:63], v227 offset:40960
  s_waitcnt lgkmcnt(7)
  v_mfma_f32_32x32x16_bf16 v[112:127], v[64:67], v[32:35], v[112:127]
  ds_read_b128 v[64:67], v228 offset:40960
  s_waitcnt lgkmcnt(7)
  v_mfma_f32_32x32x16_bf16 v[112:127], v[68:71], v[36:39], v[112:127]
  ds_read_b128 v[68:71], v229 offset:40960
  s_waitcnt lgkmcnt(7)
  v_mfma_f32_32x32x16_bf16 v[112:127], v[72:75], v[40:43], v[112:127]
  ds_read_b128 v[72:75], v230 offset:40960
  s_waitcnt lgkmcnt(7)
  v_mfma_f32_32x32x16_bf16 v[112:127], v[76:79], v[44:47], v[112:127]
  ds_read_b128 v[76:79], v231 offset:40960
  s_waitcnt lgkmcnt(7)
  v_mfma_f32_32x32x16_bf16 v[128:143], v[48:51], v[16:19], 0
  ds_read_b64_tr_b16 v[80:81], v232 offset:0
  ds_read_b64_tr_b16 v[82:83], v232 offset:2048
  s_waitcnt lgkmcnt(8)
  v_mfma_f32_32x32x16_bf16 v[128:143], v[52:55], v[20:23], v[128:143]
  ds_read_b64_tr_b16 v[84:85], v233 offset:0
  ds_read_b64_tr_b16 v[86:87], v233 offset:2048
  s_waitcnt lgkmcnt(9)
  v_mfma_f32_32x32x16_bf16 v[128:143], v[56:59], v[24:27], v[128:143]
  ds_read_b64_tr_b16 v[88:89], v234 offset:0
  ds_read_b64_tr_b16 v[90:91], v234 offset:2048
  s_waitcnt lgkmcnt(10)
  v_mfma_f32_32x32x16_bf16 v[128:143], v[60:63], v[28:31], v[128:143]
  ds_read_b64_tr_b16 v[92:93], v235 offset:0
  ds_read_b64_tr_b16 v[94:95], v235 offset:2048
  s_waitcnt lgkmcnt(11)
  v_mfma_f32_32x32x16_bf16 v[128:143], v[64:67], v[32:35], v[128:143]
  ds_read_b64_tr_b16 v[96:97], v232 offset:4096
  ds_read_b64_tr_b16 v[98:99], v232 offset:6144
  s_waitcnt lgkmcnt(12)
  v_mfma_f32_32x32x16_bf16 v[128:143], v[68:71], v[36:39], v[128:143]
  ds_read_b64_tr_b16 v[100:101], v233 offset:4096
  ds_read_b64_tr_b16 v[102:103], v233 offset:6144
  s_waitcnt lgkmcnt(13)
  v_mfma_f32_32x32x16_bf16 v[128:143], v[72:75], v[40:43], v[128:143]
  ds_read_b64_tr_b16 v[104:105], v234 offset:4096
  ds_read_b64_tr_b16 v[106:107], v234 offset:6144
  s_waitcnt lgkmcnt(13)
  v_mfma_f32_32x32x16_bf16 v[128:143], v[76:79], v[44:47], v[128:143]
  ds_read_b64_tr_b16 v[108:109], v235 offset:4096
  ds_read_b64_tr_b16 v[110:111], v235 offset:6144
  s_waitcnt lgkmcnt(8)
  v_mfma_f32_32x32x16_bf16 v[160:175], v[80:83], v[144:147], v[160:175]
  v_mfma_f32_32x32x16_bf16 v[176:191], v[84:87], v[144:147], v[176:191]
  v_mfma_f32_32x32x16_bf16 v[192:207], v[88:91], v[144:147], v[192:207]
  v_mfma_f32_32x32x16_bf16 v[208:223], v[92:95], v[144:147], v[208:223]
  ds_read_b64_tr_b16 v[80:81], v232 offset:8192
  ds_read_b64_tr_b16 v[82:83], v232 offset:10240
  ds_read_b64_tr_b16 v[84:85], v233 offset:8192
  ds_read_b64_tr_b16 v[86:87], v233 offset:10240
  ds_read_b64_tr_b16 v[88:89], v234 offset:8192
  ds_read_b64_tr_b16 v[90:91], v234 offset:10240
  ds_read_b64_tr_b16 v[92:93], v235 offset:8192
  ds_read_b64_tr_b16 v[94:95], v235 offset:10240
  s_waitcnt lgkmcnt(8)
  v_mfma_f32_32x32x16_bf16 v[160:175], v[96:99], v[148:151], v[160:175]
  v_mfma_f32_32x32x16_bf16 v[176:191], v[100:103], v[148:151], v[176:191]
  v_mfma_f32_32x32x16_bf16 v[192:207], v[104:107], v[148:151], v[192:207]
  v_mfma_f32_32x32x16_bf16 v[208:223], v[108:111], v[148:151], v[208:223]
  ds_read_b64_tr_b16 v[96:97], v232 offset:12288
  ds_read_b64_tr_b16 v[98:99], v232 offset:14336
  ds_read_b64_tr_b16 v[100:101], v233 offset:12288
  ds_read_b64_tr_b16 v[102:103], v233 offset:14336
  ds_read_b64_tr_b16 v[104:105], v234 offset:12288
  ds_read_b64_tr_b16 v[106:107], v234 offset:14336
  ds_read_b64_tr_b16 v[108:109], v235 offset:12288
  ds_read_b64_tr_b16 v[110:111], v235 offset:14336
  s_waitcnt lgkmcnt(8)
  v_mfma_f32_32x32x16_bf16 v[160:175], v[80:83], v[152:155], v[160:175]
  v_mfma_f32_32x32x16_bf16 v[176:191], v[84:87], v[152:155], v[176:191]
  v_mfma_f32_32x32x16_bf16 v[192:207], v[88:91], v[152:155], v[192:207]
  v_mfma_f32_32x32x16_bf16 v[208:223], v[92:95], v[152:155], v[208:223]
  s_waitcnt lgkmcnt(0)
  v_mfma_f32_32x32x16_bf16 v[160:175], v[96:99], v[156:159], v[160:175]
  v_mfma_f32_32x32x16_bf16 v[176:191], v[100:103], v[156:159], v[176:191]
  v_mfma_f32_32x32x16_bf16 v[192:207], v[104:107], v[156:159], v[192:207]
  v_mfma_f32_32x32x16_bf16 v[208:223], v[108:111], v[156:159], v[208:223]
  s_setprio 0
  s_waitcnt vmcnt(8)
  s_barrier
  s_add_u32 s38, s37, 32768
  s_mov_b32 m0, s38
  s_mov_b32 s39, 98304
  buffer_load_dwordx4 v236, s[28:31], s39 offen nt lds
  buffer_load_dwordx4 v237, s[28:31], s39 offen offset:1024 nt lds
  s_add_u32 s38, s37, 65536
  s_mov_b32 m0, s38
  s_mov_b32 s39, 65536
  buffer_load_dwordx4 v238, s[32:35], s39 offen nt lds
  buffer_load_dwordx4 v238, s[32:35], s39 offen offset:1024 nt lds
  v_max3_f32 v241, v112, v113, v114
  v_max3_f32 v242, v115, v116, v117
  v_max3_f32 v243, v118, v119, v120
  v_max3_f32 v244, v121, v122, v123
  v_max3_f32 v245, v124, v125, v126
  v_max3_f32 v241, v241, v242, v127
  v_max3_f32 v243, v243, v244, v245
  v_max3_f32 v242, v128, v129, v130
  v_max3_f32 v244, v131, v132, v133
  v_max3_f32 v245, v134, v135, v136
  v_max3_f32 v246, v137, v138, v139
  v_max3_f32 v247, v140, v141, v142
  v_max3_f32 v241, v241, v243, v143
  v_max3_f32 v242, v242, v244, v245
  v_max3_f32 v241, v241, v246, v247
  v_max_f32 v241, v241, v242
  v_mov_b32 v242, v241
  v_add_f32 v243, s57, v239
  s_nop 0
  v_permlane32_swap_b32 v241, v242
  v_max_f32 v241, v241, v242
  v_mul_f32 v241, s41, v241
  v_cmp_gt_f32 vcc, v241, v243
  s_nop 1
  s_cbranch_vccz L_skip_a1
  v_max_f32 v241, v239, v241
  v_sub_f32 v242, v239, v241
  v_exp_f32 v242, v242
  v_mov_b32 v239, v241
  v_mul_f32 v160, v242, v160
  v_mul_f32 v161, v242, v161
  v_mul_f32 v162, v242, v162
  v_mul_f32 v163, v242, v163
  v_mul_f32 v164, v242, v164
  v_mul_f32 v165, v242, v165
  v_mul_f32 v166, v242, v166
  v_mul_f32 v167, v242, v167
  v_mul_f32 v168, v242, v168
  v_mul_f32 v169, v242, v169
  v_mul_f32 v170, v242, v170
  v_mul_f32 v171, v242, v171
  v_mul_f32 v172, v242, v172
  v_mul_f32 v173, v242, v173
  v_mul_f32 v174, v242, v174
  v_mul_f32 v175, v242, v175
  v_mul_f32 v176, v242, v176
  v_mul_f32 v177, v242, v177
  v_mul_f32 v178, v242, v178
  v_mul_f32 v179, v242, v179
  v_mul_f32 v180, v242, v180
  v_mul_f32 v181, v242, v181
  v_mul_f32 v182, v242, v182
  v_mul_f32 v183, v242, v183
  v_mul_f32 v184, v242, v184
  v_mul_f32 v185, v242, v185
  v_mul_f32 v186, v242, v186
  v_mul_f32 v187, v242, v187
  v_mul_f32 v188, v242, v188
  v_mul_f32 v189, v242, v189
  v_mul_f32 v190, v242, v190
  v_mul_f32 v191, v242, v191
  v_mul_f32 v192, v242, v192
  v_mul_f32 v193, v242, v193
  v_mul_f32 v194, v242, v194
  v_mul_f32 v195, v242, v195
  v_mul_f32 v196, v242, v196
  v_mul_f32 v197, v242, v197
  v_mul_f32 v198, v242, v198
  v_mul_f32 v199, v242, v199
  v_mul_f32 v200, v242, v200
  v_mul_f32 v201, v242, v201
  v_mul_f32 v202, v242, v202
  v_mul_f32 v203, v242, v203
  v_mul_f32 v204, v242, v204
  v_mul_f32 v205, v242, v205
  v_mul_f32 v206, v242, v206
  v_mul_f32 v207, v242, v207
  v_mul_f32 v208, v242, v208
  v_mul_f32 v209, v242, v209
  v_mul_f32 v210, v242, v210
  v_mul_f32 v211, v242, v211
  v_mul_f32 v212, v242, v212
  v_mul_f32 v213, v242, v213
  v_mul_f32 v214, v242, v214
  v_mul_f32 v215, v242, v215
  v_mul_f32 v216, v242, v216
  v_mul_f32 v217, v242, v217
  v_mul_f32 v218, v242, v218
  v_mul_f32 v219, v242, v219
  v_mul_f32 v220, v242, v220
  v_mul_f32 v221, v242, v221
  v_mul_f32 v222, v242, v222
  v_mul_f32 v223, v242, v223
  v_mul_f32 v240, v242, v240
L_skip_a1:
  v_fma_f32 v112, v112, s41, -v239
  v_fma_f32 v113, v113, s41, -v239
  v_fma_f32 v114, v114, s41, -v239
  v_fma_f32 v115, v115, s41, -v239
  v_fma_f32 v116, v116, s41, -v239
  v_fma_f32 v117, v117, s41, -v239
  v_fma_f32 v118, v118, s41, -v239
  v_fma_f32 v119, v119, s41, -v239
  v_fma_f32 v120, v120, s41, -v239
  v_fma_f32 v121, v121, s41, -v239
  v_fma_f32 v122, v122, s41, -v239
  v_fma_f32 v123, v123, s41, -v239
  v_fma_f32 v124, v124, s41, -v239
  v_fma_f32 v125, v125, s41, -v239
  v_fma_f32 v126, v126, s41, -v239
  v_fma_f32 v127, v127, s41, -v239
  v_exp_f32 v112, v112
  v_exp_f32 v113, v113
  v_exp_f32 v114, v114
  v_exp_f32 v115, v115
  v_exp_f32 v116, v116
  v_exp_f32 v117, v117
  v_exp_f32 v118, v118
  v_exp_f32 v119, v119
  v_exp_f32 v120, v120
  v_exp_f32 v121, v121
  v_exp_f32 v122, v122
  v_exp_f32 v123, v123
  v_exp_f32 v124, v124
  v_exp_f32 v125, v125
  v_exp_f32 v126, v126
  v_exp_f32 v127, v127
  v_fma_f32 v128, v128, s41, -v239
  v_fma_f32 v129, v129, s41, -v239
  v_fma_f32 v130, v130, s41, -v239
  v_fma_f32 v131, v131, s41, -v239
  v_fma_f32 v132, v132, s41, -v239
  v_fma_f32 v133, v133, s41, -v239
  v_fma_f32 v134, v134, s41, -v239
  v_fma_f32 v135, v135, s41, -v239
  v_fma_f32 v136, v136, s41, -v239
  v_fma_f32 v137, v137, s41, -v239
  v_fma_f32 v138, v138, s41, -v239
  v_fma_f32 v139, v139, s41, -v239
  v_fma_f32 v140, v140, s41, -v239
  v_fma_f32 v141, v141, s41, -v239
  v_fma_f32 v142, v142, s41, -v239
  v_fma_f32 v143, v143, s41, -v239
  v_exp_f32 v128, v128
  v_exp_f32 v129, v129
  v_add_f32 v241, v112, v113
  v_cvt_pk_bf16_f32 v144, v112, v113
  v_add_f32 v240, v240, v241
  v_exp_f32 v130, v130
  v_exp_f32 v131, v131
  v_add_f32 v243, v114, v115
  v_cvt_pk_bf16_f32 v145, v114, v115
  v_add_f32 v240, v240, v243
  v_exp_f32 v132, v132
  v_exp_f32 v133, v133
  v_add_f32 v241, v116, v117
  v_cvt_pk_bf16_f32 v146, v116, v117
  v_add_f32 v240, v240, v241
  v_exp_f32 v134, v134
  v_exp_f32 v135, v135
  v_add_f32 v243, v118, v119
  v_cvt_pk_bf16_f32 v147, v118, v119
  v_add_f32 v240, v240, v243
  v_exp_f32 v136, v136
  v_exp_f32 v137, v137
  v_add_f32 v241, v120, v121
  v_cvt_pk_bf16_f32 v148, v120, v121
  v_add_f32 v240, v240, v241
  v_exp_f32 v138, v138
  v_exp_f32 v139, v139
  v_add_f32 v243, v122, v123
  v_cvt_pk_bf16_f32 v149, v122, v123
  v_add_f32 v240, v240, v243
  v_exp_f32 v140, v140
  v_exp_f32 v141, v141
  v_add_f32 v241, v124, v125
  v_cvt_pk_bf16_f32 v150, v124, v125
  v_add_f32 v240, v240, v241
  v_exp_f32 v142, v142
  v_exp_f32 v143, v143
  v_add_f32 v243, v126, v127
  v_cvt_pk_bf16_f32 v151, v126, v127
  v_add_f32 v240, v240, v243
  v_add_f32 v241, v128, v129
  v_cvt_pk_bf16_f32 v152, v128, v129
  v_add_f32 v240, v240, v241
  v_add_f32 v243, v130, v131
  v_cvt_pk_bf16_f32 v153, v130, v131
  v_add_f32 v240, v240, v243
  v_add_f32 v241, v132, v133
  v_cvt_pk_bf16_f32 v154, v132, v133
  v_add_f32 v240, v240, v241
  v_add_f32 v243, v134, v135
  v_cvt_pk_bf16_f32 v155, v134, v135
  v_add_f32 v240, v240, v243
  v_add_f32 v241, v136, v137
  v_cvt_pk_bf16_f32 v156, v136, v137
  v_add_f32 v240, v240, v241
  v_add_f32 v243, v138, v139
  v_cvt_pk_bf16_f32 v157, v138, v139
  v_add_f32 v240, v240, v243
  v_add_f32 v241, v140, v141
  v_cvt_pk_bf16_f32 v158, v140, v141
  v_add_f32 v240, v240, v241
  v_add_f32 v243, v142, v143
  v_cvt_pk_bf16_f32 v159, v142, v143
  v_add_f32 v240, v240, v243
  s_waitcnt vmcnt(8)
  s_barrier
  s_add_u32 s38, s37, 49152
  s_mov_b32 m0, s38
  s_mov_b32 s39, 114688
  buffer_load_dwordx4 v236, s[28:31], s39 offen nt lds
  buffer_load_dwordx4 v237, s[28:31], s39 offen offset:1024 nt lds
  s_add_u32 s38, s37, 81920
  s_mov_b32 m0, s38
  s_mov_b32 s39, 81920
  buffer_load_dwordx4 v238, s[32:35], s39 offen nt lds
  buffer_load_dwordx4 v238, s[32:35], s39 offen offset:1024 nt lds
  s_setprio 1
  ds_read_b128 v[48:51], v224 offset:0
  ds_read_b128 v[52:55], v225 offset:0
  ds_read_b128 v[56:59], v226 offset:0
  ds_read_b128 v[60:63], v227 offset:0
  ds_read_b128 v[64:67], v228 offset:0
  ds_read_b128 v[68:71], v229 offset:0
  ds_read_b128 v[72:75], v230 offset:0
  ds_read_b128 v[76:79], v231 offset:0
  s_waitcnt lgkmcnt(7)
  v_mfma_f32_32x32x16_bf16 v[112:127], v[48:51], v[16:19], 0
  ds_read_b128 v[48:51], v224 offset:8192
  s_waitcnt lgkmcnt(7)
  v_mfma_f32_32x32x16_bf16 v[112:127], v[52:55], v[20:23], v[112:127]
  ds_read_b128 v[52:55], v225 offset:8192
  s_waitcnt lgkmcnt(7)
  v_mfma_f32_32x32x16_bf16 v[112:127], v[56:59], v[24:27], v[112:127]
  ds_read_b128 v[56:59], v226 offset:8192
  s_waitcnt lgkmcnt(7)
  v_mfma_f32_32x32x16_bf16 v[112:127], v[60:63], v[28:31], v[112:127]
  ds_read_b128 v[60:63], v227 offset:8192
  s_waitcnt lgkmcnt(7)
  v_mfma_f32_32x32x16_bf16 v[112:127], v[64:67], v[32:35], v[112:127]
  ds_read_b128 v[64:67], v228 offset:8192
  s_waitcnt lgkmcnt(7)
  v_mfma_f32_32x32x16_bf16 v[112:127], v[68:71], v[36:39], v[112:127]
  ds_read_b128 v[68:71], v229 offset:8192
  s_waitcnt lgkmcnt(7)
  v_mfma_f32_32x32x16_bf16 v[112:127], v[72:75], v[40:43], v[112:127]
  ds_read_b128 v[72:75], v230 offset:8192
  s_waitcnt lgkmcnt(7)
  v_mfma_f32_32x32x16_bf16 v[112:127], v[76:79], v[44:47], v[112:127]
  ds_read_b128 v[76:79], v231 offset:8192
  s_waitcnt lgkmcnt(7)
  v_mfma_f32_32x32x16_bf16 v[128:143], v[48:51], v[16:19], 0
  ds_read_b64_tr_b16 v[80:81], v232 offset:32768
  ds_read_b64_tr_b16 v[82:83], v232 offset:34816
  s_waitcnt lgkmcnt(8)
  v_mfma_f32_32x32x16_bf16 v[128:143], v[52:55], v[20:23], v[128:143]
  ds_read_b64_tr_b16 v[84:85], v233 offset:32768
  ds_read_b64_tr_b16 v[86:87], v233 offset:34816
  s_waitcnt lgkmcnt(9)
  v_mfma_f32_32x32x16_bf16 v[128:143], v[56:59], v[24:27], v[128:143]
  ds_read_b64_tr_b16 v[88:89], v234 offset:32768
  ds_read_b64_tr_b16 v[90:91], v234 offset:34816
  s_waitcnt lgkmcnt(10)
  v_mfma_f32_32x32x16_bf16 v[128:143], v[60:63], v[28:31], v[128:143]
  ds_read_b64_tr_b16 v[92:93], v235 offset:32768
  ds_read_b64_tr_b16 v[94:95], v235 offset:34816
  s_waitcnt lgkmcnt(11)
  v_mfma_f32_32x32x16_bf16 v[128:143], v[64:67], v[32:35], v[128:143]
  ds_read_b64_tr_b16 v[96:97], v232 offset:36864
  ds_read_b64_tr_b16 v[98:99], v232 offset:38912
  s_waitcnt lgkmcnt(12)
  v_mfma_f32_32x32x16_bf16 v[128:143], v[68:71], v[36:39], v[128:143]
  ds_read_b64_tr_b16 v[100:101], v233 offset:36864
  ds_read_b64_tr_b16 v[102:103], v233 offset:38912
  s_waitcnt lgkmcnt(13)
  v_mfma_f32_32x32x16_bf16 v[128:143], v[72:75], v[40:43], v[128:143]
  ds_read_b64_tr_b16 v[104:105], v234 offset:36864
  ds_read_b64_tr_b16 v[106:107], v234 offset:38912
  s_waitcnt lgkmcnt(13)
  v_mfma_f32_32x32x16_bf16 v[128:143], v[76:79], v[44:47], v[128:143]
  ds_read_b64_tr_b16 v[108:109], v235 offset:36864
  ds_read_b64_tr_b16 v[110:111], v235 offset:38912
  s_waitcnt lgkmcnt(8)
  v_mfma_f32_32x32x16_bf16 v[160:175], v[80:83], v[144:147], v[160:175]
  v_mfma_f32_32x32x16_bf16 v[176:191], v[84:87], v[144:147], v[176:191]
  v_mfma_f32_32x32x16_bf16 v[192:207], v[88:91], v[144:147], v[192:207]
  v_mfma_f32_32x32x16_bf16 v[208:223], v[92:95], v[144:147], v[208:223]
  ds_read_b64_tr_b16 v[80:81], v232 offset:40960
  ds_read_b64_tr_b16 v[82:83], v232 offset:43008
  ds_read_b64_tr_b16 v[84:85], v233 offset:40960
  ds_read_b64_tr_b16 v[86:87], v233 offset:43008
  ds_read_b64_tr_b16 v[88:89], v234 offset:40960
  ds_read_b64_tr_b16 v[90:91], v234 offset:43008
  ds_read_b64_tr_b16 v[92:93], v235 offset:40960
  ds_read_b64_tr_b16 v[94:95], v235 offset:43008
  s_waitcnt lgkmcnt(8)
  v_mfma_f32_32x32x16_bf16 v[160:175], v[96:99], v[148:151], v[160:175]
  v_mfma_f32_32x32x16_bf16 v[176:191], v[100:103], v[148:151], v[176:191]
  v_mfma_f32_32x32x16_bf16 v[192:207], v[104:107], v[148:151], v[192:207]
  v_mfma_f32_32x32x16_bf16 v[208:223], v[108:111], v[148:151], v[208:223]
  ds_read_b64_tr_b16 v[96:97], v232 offset:45056
  ds_read_b64_tr_b16 v[98:99], v232 offset:47104
  ds_read_b64_tr_b16 v[100:101], v233 offset:45056
  ds_read_b64_tr_b16 v[102:103], v233 offset:47104
  ds_read_b64_tr_b16 v[104:105], v234 offset:45056
  ds_read_b64_tr_b16 v[106:107], v234 offset:47104
  ds_read_b64_tr_b16 v[108:109], v235 offset:45056
  ds_read_b64_tr_b16 v[110:111], v235 offset:47104
  s_waitcnt lgkmcnt(8)
  v_mfma_f32_32x32x16_bf16 v[160:175], v[80:83], v[152:155], v[160:175]
  v_mfma_f32_32x32x16_bf16 v[176:191], v[84:87], v[152:155], v[176:191]
  v_mfma_f32_32x32x16_bf16 v[192:207], v[88:91], v[152:155], v[192:207]
  v_mfma_f32_32x32x16_bf16 v[208:223], v[92:95], v[152:155], v[208:223]
  s_waitcnt lgkmcnt(0)
  v_mfma_f32_32x32x16_bf16 v[160:175], v[96:99], v[156:159], v[160:175]
  v_mfma_f32_32x32x16_bf16 v[176:191], v[100:103], v[156:159], v[176:191]
  v_mfma_f32_32x32x16_bf16 v[192:207], v[104:107], v[156:159], v[192:207]
  v_mfma_f32_32x32x16_bf16 v[208:223], v[108:111], v[156:159], v[208:223]
  s_setprio 0
  s_waitcnt vmcnt(8)
  s_barrier
  s_add_u32 s38, s37, 98304
  s_mov_b32 m0, s38
  s_mov_b32 s39, 98304
  buffer_load_dwordx4 v238, s[32:35], s39 offen nt lds
  buffer_load_dwordx4 v238, s[32:35], s39 offen offset:1024 nt lds
  v_max3_f32 v241, v112, v113, v114
  v_max3_f32 v242, v115, v116, v117
  v_max3_f32 v243, v118, v119, v120
  v_max3_f32 v244, v121, v122, v123
  v_max3_f32 v245, v124, v125, v126
  v_max3_f32 v241, v241, v242, v127
  v_max3_f32 v243, v243, v244, v245
  v_max3_f32 v242, v128, v129, v130
  v_max3_f32 v244, v131, v132, v133
  v_max3_f32 v245, v134, v135, v136
  v_max3_f32 v246, v137, v138, v139
  v_max3_f32 v247, v140, v141, v142
  v_max3_f32 v241, v241, v243, v143
  v_max3_f32 v242, v242, v244, v245
  v_max3_f32 v241, v241, v246, v247
  v_max_f32 v241, v241, v242
  v_mov_b32 v242, v241
  v_add_f32 v243, s57, v239
  s_nop 0
  v_permlane32_swap_b32 v241, v242
  v_max_f32 v241, v241, v242
  v_mul_f32 v241, s41, v241
  v_cmp_gt_f32 vcc, v241, v243
  s_nop 1
  s_cbranch_vccz L_skip_a2
  v_max_f32 v241, v239, v241
  v_sub_f32 v242, v239, v241
  v_exp_f32 v242, v242
  v_mov_b32 v239, v241
  v_mul_f32 v160, v242, v160
  v_mul_f32 v161, v242, v161
  v_mul_f32 v162, v242, v162
  v_mul_f32 v163, v242, v163
  v_mul_f32 v164, v242, v164
  v_mul_f32 v165, v242, v165
  v_mul_f32 v166, v242, v166
  v_mul_f32 v167, v242, v167
  v_mul_f32 v168, v242, v168
  v_mul_f32 v169, v242, v169
  v_mul_f32 v170, v242, v170
  v_mul_f32 v171, v242, v171
  v_mul_f32 v172, v242, v172
  v_mul_f32 v173, v242, v173
  v_mul_f32 v174, v242, v174
  v_mul_f32 v175, v242, v175
  v_mul_f32 v176, v242, v176
  v_mul_f32 v177, v242, v177
  v_mul_f32 v178, v242, v178
  v_mul_f32 v179, v242, v179
  v_mul_f32 v180, v242, v180
  v_mul_f32 v181, v242, v181
  v_mul_f32 v182, v242, v182
  v_mul_f32 v183, v242, v183
  v_mul_f32 v184, v242, v184
  v_mul_f32 v185, v242, v185
  v_mul_f32 v186, v242, v186
  v_mul_f32 v187, v242, v187
  v_mul_f32 v188, v242, v188
  v_mul_f32 v189, v242, v189
  v_mul_f32 v190, v242, v190
  v_mul_f32 v191, v242, v191
  v_mul_f32 v192, v242, v192
  v_mul_f32 v193, v242, v193
  v_mul_f32 v194, v242, v194
  v_mul_f32 v195, v242, v195
  v_mul_f32 v196, v242, v196
  v_mul_f32 v197, v242, v197
  v_mul_f32 v198, v242, v198
  v_mul_f32 v199, v242, v199
  v_mul_f32 v200, v242, v200
  v_mul_f32 v201, v242, v201
  v_mul_f32 v202, v242, v202
  v_mul_f32 v203, v242, v203
  v_mul_f32 v204, v242, v204
  v_mul_f32 v205, v242, v205
  v_mul_f32 v206, v242, v206
  v_mul_f32 v207, v242, v207
  v_mul_f32 v208, v242, v208
  v_mul_f32 v209, v242, v209
  v_mul_f32 v210, v242, v210
  v_mul_f32 v211, v242, v211
  v_mul_f32 v212, v242, v212
  v_mul_f32 v213, v242, v213
  v_mul_f32 v214, v242, v214
  v_mul_f32 v215, v242, v215
  v_mul_f32 v216, v242, v216
  v_mul_f32 v217, v242, v217
  v_mul_f32 v218, v242, v218
  v_mul_f32 v219, v242, v219
  v_mul_f32 v220, v242, v220
  v_mul_f32 v221, v242, v221
  v_mul_f32 v222, v242, v222
  v_mul_f32 v223, v242, v223
  v_mul_f32 v240, v242, v240
L_skip_a2:
  v_fma_f32 v112, v112, s41, -v239
  v_fma_f32 v113, v113, s41, -v239
  v_fma_f32 v114, v114, s41, -v239
  v_fma_f32 v115, v115, s41, -v239
  v_fma_f32 v116, v116, s41, -v239
  v_fma_f32 v117, v117, s41, -v239
  v_fma_f32 v118, v118, s41, -v239
  v_fma_f32 v119, v119, s41, -v239
  v_fma_f32 v120, v120, s41, -v239
  v_fma_f32 v121, v121, s41, -v239
  v_fma_f32 v122, v122, s41, -v239
  v_fma_f32 v123, v123, s41, -v239
  v_fma_f32 v124, v124, s41, -v239
  v_fma_f32 v125, v125, s41, -v239
  v_fma_f32 v126, v126, s41, -v239
  v_fma_f32 v127, v127, s41, -v239
  v_exp_f32 v112, v112
  v_exp_f32 v113, v113
  v_exp_f32 v114, v114
  v_exp_f32 v115, v115
  v_exp_f32 v116, v116
  v_exp_f32 v117, v117
  v_exp_f32 v118, v118
  v_exp_f32 v119, v119
  v_exp_f32 v120, v120
  v_exp_f32 v121, v121
  v_exp_f32 v122, v122
  v_exp_f32 v123, v123
  v_exp_f32 v124, v124
  v_exp_f32 v125, v125
  v_exp_f32 v126, v126
  v_exp_f32 v127, v127
  v_fma_f32 v128, v128, s41, -v239
  v_fma_f32 v129, v129, s41, -v239
  v_fma_f32 v130, v130, s41, -v239
  v_fma_f32 v131, v131, s41, -v239
  v_fma_f32 v132, v132, s41, -v239
  v_fma_f32 v133, v133, s41, -v239
  v_fma_f32 v134, v134, s41, -v239
  v_fma_f32 v135, v135, s41, -v239
  v_fma_f32 v136, v136, s41, -v239
  v_fma_f32 v137, v137, s41, -v239
  v_fma_f32 v138, v138, s41, -v239
  v_fma_f32 v139, v139, s41, -v239
  v_fma_f32 v140, v140, s41, -v239
  v_fma_f32 v141, v141, s41, -v239
  v_fma_f32 v142, v142, s41, -v239
  v_fma_f32 v143, v143, s41, -v239
  v_exp_f32 v128, v128
  v_exp_f32 v129, v129
  v_add_f32 v241, v112, v113
  v_cvt_pk_bf16_f32 v144, v112, v113
  v_add_f32 v240, v240, v241
  v_exp_f32 v130, v130
  v_exp_f32 v131, v131
  v_add_f32 v243, v114, v115
  v_cvt_pk_bf16_f32 v145, v114, v115
  v_add_f32 v240, v240, v243
  v_exp_f32 v132, v132
  v_exp_f32 v133, v133
  v_add_f32 v241, v116, v117
  v_cvt_pk_bf16_f32 v146, v116, v117
  v_add_f32 v240, v240, v241
  v_exp_f32 v134, v134
  v_exp_f32 v135, v135
  v_add_f32 v243, v118, v119
  v_cvt_pk_bf16_f32 v147, v118, v119
  v_add_f32 v240, v240, v243
  v_exp_f32 v136, v136
  v_exp_f32 v137, v137
  v_add_f32 v241, v120, v121
  v_cvt_pk_bf16_f32 v148, v120, v121
  v_add_f32 v240, v240, v241
  v_exp_f32 v138, v138
  v_exp_f32 v139, v139
  v_add_f32 v243, v122, v123
  v_cvt_pk_bf16_f32 v149, v122, v123
  v_add_f32 v240, v240, v243
  v_exp_f32 v140, v140
  v_exp_f32 v141, v141
  v_add_f32 v241, v124, v125
  v_cvt_pk_bf16_f32 v150, v124, v125
  v_add_f32 v240, v240, v241
  v_exp_f32 v142, v142
  v_exp_f32 v143, v143
  v_add_f32 v243, v126, v127
  v_cvt_pk_bf16_f32 v151, v126, v127
  v_add_f32 v240, v240, v243
  v_add_f32 v241, v128, v129
  v_cvt_pk_bf16_f32 v152, v128, v129
  v_add_f32 v240, v240, v241
  v_add_f32 v243, v130, v131
  v_cvt_pk_bf16_f32 v153, v130, v131
  v_add_f32 v240, v240, v243
  v_add_f32 v241, v132, v133
  v_cvt_pk_bf16_f32 v154, v132, v133
  v_add_f32 v240, v240, v241
  v_add_f32 v243, v134, v135
  v_cvt_pk_bf16_f32 v155, v134, v135
  v_add_f32 v240, v240, v243
  v_add_f32 v241, v136, v137
  v_cvt_pk_bf16_f32 v156, v136, v137
  v_add_f32 v240, v240, v241
  v_add_f32 v243, v138, v139
  v_cvt_pk_bf16_f32 v157, v138, v139
  v_add_f32 v240, v240, v243
  v_add_f32 v241, v140, v141
  v_cvt_pk_bf16_f32 v158, v140, v141
  v_add_f32 v240, v240, v241
  v_add_f32 v243, v142, v143
  v_cvt_pk_bf16_f32 v159, v142, v143
  v_add_f32 v240, v240, v243
  s_waitcnt vmcnt(6)
  s_barrier
  s_add_u32 s38, s37, 114688
  s_mov_b32 m0, s38
  s_mov_b32 s39, 114688
  buffer_load_dwordx4 v238, s[32:35], s39 offen nt lds
  buffer_load_dwordx4 v238, s[32:35], s39 offen offset:1024 nt lds
  s_setprio 1
  ds_read_b128 v[48:51], v224 offset:32768
  ds_read_b128 v[52:55], v225 offset:32768
  ds_read_b128 v[56:59], v226 offset:32768
  ds_read_b128 v[60:63], v227 offset:32768
  ds_read_b128 v[64:67], v228 offset:32768
  ds_read_b128 v[68:71], v229 offset:32768
  ds_read_b128 v[72:75], v230 offset:32768
  ds_read_b128 v[76:79], v231 offset:32768
  s_waitcnt lgkmcnt(7)
  v_mfma_f32_32x32x16_bf16 v[112:127], v[48:51], v[16:19], 0
  ds_read_b128 v[48:51], v224 offset:40960
  s_waitcnt lgkmcnt(7)
  v_mfma_f32_32x32x16_bf16 v[112:127], v[52:55], v[20:23], v[112:127]
  ds_read_b128 v[52:55], v225 offset:40960
  s_waitcnt lgkmcnt(7)
  v_mfma_f32_32x32x16_bf16 v[112:127], v[56:59], v[24:27], v[112:127]
  ds_read_b128 v[56:59], v226 offset:40960
  s_waitcnt lgkmcnt(7)
  v_mfma_f32_32x32x16_bf16 v[112:127], v[60:63], v[28:31], v[112:127]
  ds_read_b128 v[60:63], v227 offset:40960
  s_waitcnt lgkmcnt(7)
  v_mfma_f32_32x32x16_bf16 v[112:127], v[64:67], v[32:35], v[112:127]
  ds_read_b128 v[64:67], v228 offset:40960
  s_waitcnt lgkmcnt(7)
  v_mfma_f32_32x32x16_bf16 v[112:127], v[68:71], v[36:39], v[112:127]
  ds_read_b128 v[68:71], v229 offset:40960
  s_waitcnt lgkmcnt(7)
  v_mfma_f32_32x32x16_bf16 v[112:127], v[72:75], v[40:43], v[112:127]
  ds_read_b128 v[72:75], v230 offset:40960
  s_waitcnt lgkmcnt(7)
  v_mfma_f32_32x32x16_bf16 v[112:127], v[76:79], v[44:47], v[112:127]
  ds_read_b128 v[76:79], v231 offset:40960
  s_waitcnt lgkmcnt(7)
  v_mfma_f32_32x32x16_bf16 v[128:143], v[48:51], v[16:19], 0
  ds_read_b64_tr_b16 v[80:81], v232 offset:0
  ds_read_b64_tr_b16 v[82:83], v232 offset:2048
  s_waitcnt lgkmcnt(8)
  v_mfma_f32_32x32x16_bf16 v[128:143], v[52:55], v[20:23], v[128:143]
  ds_read_b64_tr_b16 v[84:85], v233 offset:0
  ds_read_b64_tr_b16 v[86:87], v233 offset:2048
  s_waitcnt lgkmcnt(9)
  v_mfma_f32_32x32x16_bf16 v[128:143], v[56:59], v[24:27], v[128:143]
  ds_read_b64_tr_b16 v[88:89], v234 offset:0
  ds_read_b64_tr_b16 v[90:91], v234 offset:2048
  s_waitcnt lgkmcnt(10)
  v_mfma_f32_32x32x16_bf16 v[128:143], v[60:63], v[28:31], v[128:143]
  ds_read_b64_tr_b16 v[92:93], v235 offset:0
  ds_read_b64_tr_b16 v[94:95], v235 offset:2048
  s_waitcnt lgkmcnt(11)
  v_mfma_f32_32x32x16_bf16 v[128:143], v[64:67], v[32:35], v[128:143]
  ds_read_b64_tr_b16 v[96:97], v232 offset:4096
  ds_read_b64_tr_b16 v[98:99], v232 offset:6144
  s_waitcnt lgkmcnt(12)
  v_mfma_f32_32x32x16_bf16 v[128:143], v[68:71], v[36:39], v[128:143]
  ds_read_b64_tr_b16 v[100:101], v233 offset:4096
  ds_read_b64_tr_b16 v[102:103], v233 offset:6144
  s_waitcnt lgkmcnt(13)
  v_mfma_f32_32x32x16_bf16 v[128:143], v[72:75], v[40:43], v[128:143]
  ds_read_b64_tr_b16 v[104:105], v234 offset:4096
  ds_read_b64_tr_b16 v[106:107], v234 offset:6144
  s_waitcnt lgkmcnt(13)
  v_mfma_f32_32x32x16_bf16 v[128:143], v[76:79], v[44:47], v[128:143]
  ds_read_b64_tr_b16 v[108:109], v235 offset:4096
  ds_read_b64_tr_b16 v[110:111], v235 offset:6144
  s_waitcnt lgkmcnt(8)
  v_mfma_f32_32x32x16_bf16 v[160:175], v[80:83], v[144:147], v[160:175]
  v_mfma_f32_32x32x16_bf16 v[176:191], v[84:87], v[144:147], v[176:191]
  v_mfma_f32_32x32x16_bf16 v[192:207], v[88:91], v[144:147], v[192:207]
  v_mfma_f32_32x32x16_bf16 v[208:223], v[92:95], v[144:147], v[208:223]
  ds_read_b64_tr_b16 v[80:81], v232 offset:8192
  ds_read_b64_tr_b16 v[82:83], v232 offset:10240
  ds_read_b64_tr_b16 v[84:85], v233 offset:8192
  ds_read_b64_tr_b16 v[86:87], v233 offset:10240
  ds_read_b64_tr_b16 v[88:89], v234 offset:8192
  ds_read_b64_tr_b16 v[90:91], v234 offset:10240
  ds_read_b64_tr_b16 v[92:93], v235 offset:8192
  ds_read_b64_tr_b16 v[94:95], v235 offset:10240
  s_waitcnt lgkmcnt(8)
  v_mfma_f32_32x32x16_bf16 v[160:175], v[96:99], v[148:151], v[160:175]
  v_mfma_f32_32x32x16_bf16 v[176:191], v[100:103], v[148:151], v[176:191]
  v_mfma_f32_32x32x16_bf16 v[192:207], v[104:107], v[148:151], v[192:207]
  v_mfma_f32_32x32x16_bf16 v[208:223], v[108:111], v[148:151], v[208:223]
  ds_read_b64_tr_b16 v[96:97], v232 offset:12288
  ds_read_b64_tr_b16 v[98:99], v232 offset:14336
  ds_read_b64_tr_b16 v[100:101], v233 offset:12288
  ds_read_b64_tr_b16 v[102:103], v233 offset:14336
  ds_read_b64_tr_b16 v[104:105], v234 offset:12288
  ds_read_b64_tr_b16 v[106:107], v234 offset:14336
  ds_read_b64_tr_b16 v[108:109], v235 offset:12288
  ds_read_b64_tr_b16 v[110:111], v235 offset:14336
  s_waitcnt lgkmcnt(8)
  v_mfma_f32_32x32x16_bf16 v[160:175], v[80:83], v[152:155], v[160:175]
  v_mfma_f32_32x32x16_bf16 v[176:191], v[84:87], v[152:155], v[176:191]
  v_mfma_f32_32x32x16_bf16 v[192:207], v[88:91], v[152:155], v[192:207]
  v_mfma_f32_32x32x16_bf16 v[208:223], v[92:95], v[152:155], v[208:223]
  s_waitcnt lgkmcnt(0)
  v_mfma_f32_32x32x16_bf16 v[160:175], v[96:99], v[156:159], v[160:175]
  v_mfma_f32_32x32x16_bf16 v[176:191], v[100:103], v[156:159], v[176:191]
  v_mfma_f32_32x32x16_bf16 v[192:207], v[104:107], v[156:159], v[192:207]
  v_mfma_f32_32x32x16_bf16 v[208:223], v[108:111], v[156:159], v[208:223]
  s_setprio 0
  s_waitcnt vmcnt(4)
  s_barrier
  v_max3_f32 v241, v112, v113, v114
  v_max3_f32 v242, v115, v116, v117
  v_max3_f32 v243, v118, v119, v120
  v_max3_f32 v244, v121, v122, v123
  v_max3_f32 v245, v124, v125, v126
  v_max3_f32 v241, v241, v242, v127
  v_max3_f32 v243, v243, v244, v245
  v_max3_f32 v242, v128, v129, v130
  v_max3_f32 v244, v131, v132, v133
  v_max3_f32 v245, v134, v135, v136
  v_max3_f32 v246, v137, v138, v139
  v_max3_f32 v247, v140, v141, v142
  v_max3_f32 v241, v241, v243, v143
  v_max3_f32 v242, v242, v244, v245
  v_max3_f32 v241, v241, v246, v247
  v_max_f32 v241, v241, v242
  v_mov_b32 v242, v241
  v_add_f32 v243, s57, v239
  s_nop 0
  v_permlane32_swap_b32 v241, v242
  v_max_f32 v241, v241, v242
  v_mul_f32 v241, s41, v241
  v_cmp_gt_f32 vcc, v241, v243
  s_nop 1
  s_cbranch_vccz L_skip_a3
  v_max_f32 v241, v239, v241
  v_sub_f32 v242, v239, v241
  v_exp_f32 v242, v242
  v_mov_b32 v239, v241
  v_mul_f32 v160, v242, v160
  v_mul_f32 v161, v242, v161
  v_mul_f32 v162, v242, v162
  v_mul_f32 v163, v242, v163
  v_mul_f32 v164, v242, v164
  v_mul_f32 v165, v242, v165
  v_mul_f32 v166, v242, v166
  v_mul_f32 v167, v242, v167
  v_mul_f32 v168, v242, v168
  v_mul_f32 v169, v242, v169
  v_mul_f32 v170, v242, v170
  v_mul_f32 v171, v242, v171
  v_mul_f32 v172, v242, v172
  v_mul_f32 v173, v242, v173
  v_mul_f32 v174, v242, v174
  v_mul_f32 v175, v242, v175
  v_mul_f32 v176, v242, v176
  v_mul_f32 v177, v242, v177
  v_mul_f32 v178, v242, v178
  v_mul_f32 v179, v242, v179
  v_mul_f32 v180, v242, v180
  v_mul_f32 v181, v242, v181
  v_mul_f32 v182, v242, v182
  v_mul_f32 v183, v242, v183
  v_mul_f32 v184, v242, v184
  v_mul_f32 v185, v242, v185
  v_mul_f32 v186, v242, v186
  v_mul_f32 v187, v242, v187
  v_mul_f32 v188, v242, v188
  v_mul_f32 v189, v242, v189
  v_mul_f32 v190, v242, v190
  v_mul_f32 v191, v242, v191
  v_mul_f32 v192, v242, v192
  v_mul_f32 v193, v242, v193
  v_mul_f32 v194, v242, v194
  v_mul_f32 v195, v242, v195
  v_mul_f32 v196, v242, v196
  v_mul_f32 v197, v242, v197
  v_mul_f32 v198, v242, v198
  v_mul_f32 v199, v242, v199
  v_mul_f32 v200, v242, v200
  v_mul_f32 v201, v242, v201
  v_mul_f32 v202, v242, v202
  v_mul_f32 v203, v242, v203
  v_mul_f32 v204, v242, v204
  v_mul_f32 v205, v242, v205
  v_mul_f32 v206, v242, v206
  v_mul_f32 v207, v242, v207
  v_mul_f32 v208, v242, v208
  v_mul_f32 v209, v242, v209
  v_mul_f32 v210, v242, v210
  v_mul_f32 v211, v242, v211
  v_mul_f32 v212, v242, v212
  v_mul_f32 v213, v242, v213
  v_mul_f32 v214, v242, v214
  v_mul_f32 v215, v242, v215
  v_mul_f32 v216, v242, v216
  v_mul_f32 v217, v242, v217
  v_mul_f32 v218, v242, v218
  v_mul_f32 v219, v242, v219
  v_mul_f32 v220, v242, v220
  v_mul_f32 v221, v242, v221
  v_mul_f32 v222, v242, v222
  v_mul_f32 v223, v242, v223
  v_mul_f32 v240, v242, v240
L_skip_a3:
  v_fma_f32 v112, v112, s41, -v239
  v_fma_f32 v113, v113, s41, -v239
  v_fma_f32 v114, v114, s41, -v239
  v_fma_f32 v115, v115, s41, -v239
  v_fma_f32 v116, v116, s41, -v239
  v_fma_f32 v117, v117, s41, -v239
  v_fma_f32 v118, v118, s41, -v239
  v_fma_f32 v119, v119, s41, -v239
  v_fma_f32 v120, v120, s41, -v239
  v_fma_f32 v121, v121, s41, -v239
  v_fma_f32 v122, v122, s41, -v239
  v_fma_f32 v123, v123, s41, -v239
  v_fma_f32 v124, v124, s41, -v239
  v_fma_f32 v125, v125, s41, -v239
  v_fma_f32 v126, v126, s41, -v239
  v_fma_f32 v127, v127, s41, -v239
  v_exp_f32 v112, v112
  v_exp_f32 v113, v113
  v_exp_f32 v114, v114
  v_exp_f32 v115, v115
  v_exp_f32 v116, v116
  v_exp_f32 v117, v117
  v_exp_f32 v118, v118
  v_exp_f32 v119, v119
  v_exp_f32 v120, v120
  v_exp_f32 v121, v121
  v_exp_f32 v122, v122
  v_exp_f32 v123, v123
  v_exp_f32 v124, v124
  v_exp_f32 v125, v125
  v_exp_f32 v126, v126
  v_exp_f32 v127, v127
  v_fma_f32 v128, v128, s41, -v239
  v_fma_f32 v129, v129, s41, -v239
  v_fma_f32 v130, v130, s41, -v239
  v_fma_f32 v131, v131, s41, -v239
  v_fma_f32 v132, v132, s41, -v239
  v_fma_f32 v133, v133, s41, -v239
  v_fma_f32 v134, v134, s41, -v239
  v_fma_f32 v135, v135, s41, -v239
  v_fma_f32 v136, v136, s41, -v239
  v_fma_f32 v137, v137, s41, -v239
  v_fma_f32 v138, v138, s41, -v239
  v_fma_f32 v139, v139, s41, -v239
  v_fma_f32 v140, v140, s41, -v239
  v_fma_f32 v141, v141, s41, -v239
  v_fma_f32 v142, v142, s41, -v239
  v_fma_f32 v143, v143, s41, -v239
  v_exp_f32 v128, v128
  v_exp_f32 v129, v129
  v_add_f32 v241, v112, v113
  v_cvt_pk_bf16_f32 v144, v112, v113
  v_add_f32 v240, v240, v241
  v_exp_f32 v130, v130
  v_exp_f32 v131, v131
  v_add_f32 v243, v114, v115
  v_cvt_pk_bf16_f32 v145, v114, v115
  v_add_f32 v240, v240, v243
  v_exp_f32 v132, v132
  v_exp_f32 v133, v133
  v_add_f32 v241, v116, v117
  v_cvt_pk_bf16_f32 v146, v116, v117
  v_add_f32 v240, v240, v241
  v_exp_f32 v134, v134
  v_exp_f32 v135, v135
  v_add_f32 v243, v118, v119
  v_cvt_pk_bf16_f32 v147, v118, v119
  v_add_f32 v240, v240, v243
  v_exp_f32 v136, v136
  v_exp_f32 v137, v137
  v_add_f32 v241, v120, v121
  v_cvt_pk_bf16_f32 v148, v120, v121
  v_add_f32 v240, v240, v241
  v_exp_f32 v138, v138
  v_exp_f32 v139, v139
  v_add_f32 v243, v122, v123
  v_cvt_pk_bf16_f32 v149, v122, v123
  v_add_f32 v240, v240, v243
  v_exp_f32 v140, v140
  v_exp_f32 v141, v141
  v_add_f32 v241, v124, v125
  v_cvt_pk_bf16_f32 v150, v124, v125
  v_add_f32 v240, v240, v241
  v_exp_f32 v142, v142
  v_exp_f32 v143, v143
  v_add_f32 v243, v126, v127
  v_cvt_pk_bf16_f32 v151, v126, v127
  v_add_f32 v240, v240, v243
  v_add_f32 v241, v128, v129
  v_cvt_pk_bf16_f32 v152, v128, v129
  v_add_f32 v240, v240, v241
  v_add_f32 v243, v130, v131
  v_cvt_pk_bf16_f32 v153, v130, v131
  v_add_f32 v240, v240, v243
  v_add_f32 v241, v132, v133
  v_cvt_pk_bf16_f32 v154, v132, v133
  v_add_f32 v240, v240, v241
  v_add_f32 v243, v134, v135
  v_cvt_pk_bf16_f32 v155, v134, v135
  v_add_f32 v240, v240, v243
  v_add_f32 v241, v136, v137
  v_cvt_pk_bf16_f32 v156, v136, v137
  v_add_f32 v240, v240, v241
  v_add_f32 v243, v138, v139
  v_cvt_pk_bf16_f32 v157, v138, v139
  v_add_f32 v240, v240, v243
  v_add_f32 v241, v140, v141
  v_cvt_pk_bf16_f32 v158, v140, v141
  v_add_f32 v240, v240, v241
  v_add_f32 v243, v142, v143
  v_cvt_pk_bf16_f32 v159, v142, v143
  v_add_f32 v240, v240, v243
  s_waitcnt vmcnt(2)
  s_barrier
  s_setprio 1
  ds_read_b64_tr_b16 v[80:81], v232 offset:32768
  ds_read_b64_tr_b16 v[82:83], v232 offset:34816
  ds_read_b64_tr_b16 v[84:85], v233 offset:32768
  ds_read_b64_tr_b16 v[86:87], v233 offset:34816
  ds_read_b64_tr_b16 v[88:89], v234 offset:32768
  ds_read_b64_tr_b16 v[90:91], v234 offset:34816
  ds_read_b64_tr_b16 v[92:93], v235 offset:32768
  ds_read_b64_tr_b16 v[94:95], v235 offset:34816
  ds_read_b64_tr_b16 v[96:97], v232 offset:36864
  ds_read_b64_tr_b16 v[98:99], v232 offset:38912
  ds_read_b64_tr_b16 v[100:101], v233 offset:36864
  ds_read_b64_tr_b16 v[102:103], v233 offset:38912
  ds_read_b64_tr_b16 v[104:105], v234 offset:36864
  ds_read_b64_tr_b16 v[106:107], v234 offset:38912
  ds_read_b64_tr_b16 v[108:109], v235 offset:36864
  ds_read_b64_tr_b16 v[110:111], v235 offset:38912
  s_waitcnt lgkmcnt(8)
  v_mfma_f32_32x32x16_bf16 v[160:175], v[80:83], v[144:147], v[160:175]
  v_mfma_f32_32x32x16_bf16 v[176:191], v[84:87], v[144:147], v[176:191]
  v_mfma_f32_32x32x16_bf16 v[192:207], v[88:91], v[144:147], v[192:207]
  v_mfma_f32_32x32x16_bf16 v[208:223], v[92:95], v[144:147], v[208:223]
  ds_read_b64_tr_b16 v[80:81], v232 offset:40960
  ds_read_b64_tr_b16 v[82:83], v232 offset:43008
  ds_read_b64_tr_b16 v[84:85], v233 offset:40960
  ds_read_b64_tr_b16 v[86:87], v233 offset:43008
  ds_read_b64_tr_b16 v[88:89], v234 offset:40960
  ds_read_b64_tr_b16 v[90:91], v234 offset:43008
  ds_read_b64_tr_b16 v[92:93], v235 offset:40960
  ds_read_b64_tr_b16 v[94:95], v235 offset:43008
  s_waitcnt lgkmcnt(8)
  v_mfma_f32_32x32x16_bf16 v[160:175], v[96:99], v[148:151], v[160:175]
  v_mfma_f32_32x32x16_bf16 v[176:191], v[100:103], v[148:151], v[176:191]
  v_mfma_f32_32x32x16_bf16 v[192:207], v[104:107], v[148:151], v[192:207]
  v_mfma_f32_32x32x16_bf16 v[208:223], v[108:111], v[148:151], v[208:223]
  ds_read_b64_tr_b16 v[96:97], v232 offset:45056
  ds_read_b64_tr_b16 v[98:99], v232 offset:47104
  ds_read_b64_tr_b16 v[100:101], v233 offset:45056
  ds_read_b64_tr_b16 v[102:103], v233 offset:47104
  ds_read_b64_tr_b16 v[104:105], v234 offset:45056
  ds_read_b64_tr_b16 v[106:107], v234 offset:47104
  ds_read_b64_tr_b16 v[108:109], v235 offset:45056
  ds_read_b64_tr_b16 v[110:111], v235 offset:47104
  s_waitcnt lgkmcnt(8)
  v_mfma_f32_32x32x16_bf16 v[160:175], v[80:83], v[152:155], v[160:175]
  v_mfma_f32_32x32x16_bf16 v[176:191], v[84:87], v[152:155], v[176:191]
  v_mfma_f32_32x32x16_bf16 v[192:207], v[88:91], v[152:155], v[192:207]
  v_mfma_f32_32x32x16_bf16 v[208:223], v[92:95], v[152:155], v[208:223]
  s_waitcnt lgkmcnt(0)
  v_mfma_f32_32x32x16_bf16 v[160:175], v[96:99], v[156:159], v[160:175]
  v_mfma_f32_32x32x16_bf16 v[176:191], v[100:103], v[156:159], v[176:191]
  v_mfma_f32_32x32x16_bf16 v[192:207], v[104:107], v[156:159], v[192:207]
  v_mfma_f32_32x32x16_bf16 v[208:223], v[108:111], v[156:159], v[208:223]
  s_setprio 0
  s_waitcnt vmcnt(0)
  s_barrier
  s_branch L_epi
L_groupB:
  s_waitcnt vmcnt(6)
  s_barrier
  s_add_u32 s38, s37, 49152
  s_mov_b32 m0, s38
  s_mov_b32 s39, 49152
  buffer_load_dwordx4 v236, s[28:31], s39 offen nt lds
  buffer_load_dwordx4 v237, s[28:31], s39 offen offset:1024 nt lds
  s_add_u32 s38, s37, 81920
  s_mov_b32 m0, s38
  s_mov_b32 s39, 16384
  buffer_load_dwordx4 v238, s[32:35], s39 offen nt lds
  buffer_load_dwordx4 v238, s[32:35], s39 offen offset:1024 nt lds
  s_waitcnt vmcnt(8)
  s_barrier
  s_add_u32 s38, s37, 0
  s_mov_b32 m0, s38
  s_mov_b32 s39, 65536
  buffer_load_dwordx4 v236, s[28:31], s39 offen nt lds
  buffer_load_dwordx4 v237, s[28:31], s39 offen offset:1024 nt lds
  s_add_u32 s38, s37, 98304
  s_mov_b32 m0, s38
  s_mov_b32 s39, 32768
  buffer_load_dwordx4 v238, s[32:35], s39 offen nt lds
  buffer_load_dwordx4 v238, s[32:35], s39 offen offset:1024 nt lds
  s_setprio 1
  ds_read_b128 v[48:51], v224 offset:16384
  ds_read_b128 v[52:55], v225 offset:16384
  ds_read_b128 v[56:59], v226 offset:16384
  ds_read_b128 v[60:63], v227 offset:16384
  ds_read_b128 v[64:67], v228 offset:16384
  ds_read_b128 v[68:71], v229 offset:16384
  ds_read_b128 v[72:75], v230 offset:16384
  ds_read_b128 v[76:79], v231 offset:16384
  s_waitcnt lgkmcnt(7)
  v_mfma_f32_32x32x16_bf16 v[112:127], v[48:51], v[16:19], 0
  ds_read_b128 v[48:51], v224 offset:24576
  s_waitcnt lgkmcnt(7)
  v_mfma_f32_32x32x16_bf16 v[112:127], v[52:55], v[20:23], v[112:127]
  ds_read_b128 v[52:55], v225 offset:24576
  s_waitcnt lgkmcnt(7)
  v_mfma_f32_32x32x16_bf16 v[112:127], v[56:59], v[24:27], v[112:127]
  ds_read_b128 v[56:59], v226 offset:24576
  s_waitcnt lgkmcnt(7)
  v_mfma_f32_32x32x16_bf16 v[112:127], v[60:63], v[28:31], v[112:127]
  ds_read_b128 v[60:63], v227 offset:24576
  s_waitcnt lgkmcnt(7)
  v_mfma_f32_32x32x16_bf16 v[112:127], v[64:67], v[32:35], v[112:127]
  ds_read_b128 v[64:67], v228 offset:24576
  s_waitcnt lgkmcnt(7)
  v_mfma_f32_32x32x16_bf16 v[112:127], v[68:71], v[36:39], v[112:127]
  ds_read_b128 v[68:71], v229 offset:24576
  s_waitcnt lgkmcnt(7)
  v_mfma_f32_32x32x16_bf16 v[112:127], v[72:75], v[40:43], v[112:127]
  ds_read_b128 v[72:75], v230 offset:24576
  s_waitcnt lgkmcnt(7)
  v_mfma_f32_32x32x16_bf16 v[112:127], v[76:79], v[44:47], v[112:127]
  ds_read_b128 v[76:79], v231 offset:24576
  s_waitcnt lgkmcnt(7)
  v_mfma_f32_32x32x16_bf16 v[128:143], v[48:51], v[16:19], 0
  s_waitcnt lgkmcnt(6)
  v_mfma_f32_32x32x16_bf16 v[128:143], v[52:55], v[20:23], v[128:143]
  s_waitcnt lgkmcnt(5)
  v_mfma_f32_32x32x16_bf16 v[128:143], v[56:59], v[24:27], v[128:143]
  s_waitcnt lgkmcnt(4)
  v_mfma_f32_32x32x16_bf16 v[128:143], v[60:63], v[28:31], v[128:143]
  s_waitcnt lgkmcnt(3)
  v_mfma_f32_32x32x16_bf16 v[128:143], v[64:67], v[32:35], v[128:143]
  s_waitcnt lgkmcnt(2)
  v_mfma_f32_32x32x16_bf16 v[128:143], v[68:71], v[36:39], v[128:143]
  s_waitcnt lgkmcnt(1)
  v_mfma_f32_32x32x16_bf16 v[128:143], v[72:75], v[40:43], v[128:143]
  s_waitcnt lgkmcnt(0)
  v_mfma_f32_32x32x16_bf16 v[128:143], v[76:79], v[44:47], v[128:143]
  s_setprio 0
  s_waitcnt vmcnt(8)
  s_barrier
  s_add_u32 s38, s37, 16384
  s_mov_b32 m0, s38
  s_mov_b32 s39, 81920
  buffer_load_dwordx4 v236, s[28:31], s39 offen nt lds
  buffer_load_dwordx4 v237, s[28:31], s39 offen offset:1024 nt lds
  s_add_u32 s38, s37, 114688
  s_mov_b32 m0, s38
  s_mov_b32 s39, 49152
  buffer_load_dwordx4 v238, s[32:35], s39 offen nt lds
  buffer_load_dwordx4 v238, s[32:35], s39 offen offset:1024 nt lds
  v_max3_f32 v241, v112, v113, v114
  v_max3_f32 v242, v115, v116, v117
  v_max3_f32 v243, v118, v119, v120
  v_max3_f32 v244, v121, v122, v123
  v_max3_f32 v245, v124, v125, v126
  v_max3_f32 v241, v241, v242, v127
  v_max3_f32 v243, v243, v244, v245
  v_max3_f32 v242, v128, v129, v130
  v_max3_f32 v244, v131, v132, v133
  v_max3_f32 v245, v134, v135, v136
  v_max3_f32 v246, v137, v138, v139
  v_max3_f32 v247, v140, v141, v142
  v_max3_f32 v241, v241, v243, v143
  v_max3_f32 v242, v242, v244, v245
  v_max3_f32 v241, v241, v246, v247
  v_max_f32 v241, v241, v242
  v_mov_b32 v242, v241
  v_add_f32 v243, s57, v239
  s_nop 0
  v_permlane32_swap_b32 v241, v242
  v_max_f32 v241, v241, v242
  v_mul_f32 v241, s41, v241
  v_cmp_gt_f32 vcc, v241, v243
  s_nop 1
  s_cbranch_vccz L_skip_b0
  v_max_f32 v241, v239, v241
  v_sub_f32 v242, v239, v241
  v_exp_f32 v242, v242
  v_mov_b32 v239, v241
  v_mul_f32 v160, v242, v160
  v_mul_f32 v161, v242, v161
  v_mul_f32 v162, v242, v162
  v_mul_f32 v163, v242, v163
  v_mul_f32 v164, v242, v164
  v_mul_f32 v165, v242, v165
  v_mul_f32 v166, v242, v166
  v_mul_f32 v167, v242, v167
  v_mul_f32 v168, v242, v168
  v_mul_f32 v169, v242, v169
  v_mul_f32 v170, v242, v170
  v_mul_f32 v171, v242, v171
  v_mul_f32 v172, v242, v172
  v_mul_f32 v173, v242, v173
  v_mul_f32 v174, v242, v174
  v_mul_f32 v175, v242, v175
  v_mul_f32 v176, v242, v176
  v_mul_f32 v177, v242, v177
  v_mul_f32 v178, v242, v178
  v_mul_f32 v179, v242, v179
  v_mul_f32 v180, v242, v180
  v_mul_f32 v181, v242, v181
  v_mul_f32 v182, v242, v182
  v_mul_f32 v183, v242, v183
  v_mul_f32 v184, v242, v184
  v_mul_f32 v185, v242, v185
  v_mul_f32 v186, v242, v186
  v_mul_f32 v187, v242, v187
  v_mul_f32 v188, v242, v188
  v_mul_f32 v189, v242, v189
  v_mul_f32 v190, v242, v190
  v_mul_f32 v191, v242, v191
  v_mul_f32 v192, v242, v192
  v_mul_f32 v193, v242, v193
  v_mul_f32 v194, v242, v194
  v_mul_f32 v195, v242, v195
  v_mul_f32 v196, v242, v196
  v_mul_f32 v197, v242, v197
  v_mul_f32 v198, v242, v198
  v_mul_f32 v199, v242, v199
  v_mul_f32 v200, v242, v200
  v_mul_f32 v201, v242, v201
  v_mul_f32 v202, v242, v202
  v_mul_f32 v203, v242, v203
  v_mul_f32 v204, v242, v204
  v_mul_f32 v205, v242, v205
  v_mul_f32 v206, v242, v206
  v_mul_f32 v207, v242, v207
  v_mul_f32 v208, v242, v208
  v_mul_f32 v209, v242, v209
  v_mul_f32 v210, v242, v210
  v_mul_f32 v211, v242, v211
  v_mul_f32 v212, v242, v212
  v_mul_f32 v213, v242, v213
  v_mul_f32 v214, v242, v214
  v_mul_f32 v215, v242, v215
  v_mul_f32 v216, v242, v216
  v_mul_f32 v217, v242, v217
  v_mul_f32 v218, v242, v218
  v_mul_f32 v219, v242, v219
  v_mul_f32 v220, v242, v220
  v_mul_f32 v221, v242, v221
  v_mul_f32 v222, v242, v222
  v_mul_f32 v223, v242, v223
  v_mul_f32 v240, v242, v240
L_skip_b0:
  v_fma_f32 v112, v112, s41, -v239
  v_fma_f32 v113, v113, s41, -v239
  v_fma_f32 v114, v114, s41, -v239
  v_fma_f32 v115, v115, s41, -v239
  v_fma_f32 v116, v116, s41, -v239
  v_fma_f32 v117, v117, s41, -v239
  v_fma_f32 v118, v118, s41, -v239
  v_fma_f32 v119, v119, s41, -v239
  v_fma_f32 v120, v120, s41, -v239
  v_fma_f32 v121, v121, s41, -v239
  v_fma_f32 v122, v122, s41, -v239
  v_fma_f32 v123, v123, s41, -v239
  v_fma_f32 v124, v124, s41, -v239
  v_fma_f32 v125, v125, s41, -v239
  v_fma_f32 v126, v126, s41, -v239
  v_fma_f32 v127, v127, s41, -v239
  v_exp_f32 v112, v112
  v_exp_f32 v113, v113
  v_exp_f32 v114, v114
  v_exp_f32 v115, v115
  v_exp_f32 v116, v116
  v_exp_f32 v117, v117
  v_exp_f32 v118, v118
  v_exp_f32 v119, v119
  v_exp_f32 v120, v120
  v_exp_f32 v121, v121
  v_exp_f32 v122, v122
  v_exp_f32 v123, v123
  v_exp_f32 v124, v124
  v_exp_f32 v125, v125
  v_exp_f32 v126, v126
  v_exp_f32 v127, v127
  v_fma_f32 v128, v128, s41, -v239
  v_fma_f32 v129, v129, s41, -v239
  v_fma_f32 v130, v130, s41, -v239
  v_fma_f32 v131, v131, s41, -v239
  v_fma_f32 v132, v132, s41, -v239
  v_fma_f32 v133, v133, s41, -v239
  v_fma_f32 v134, v134, s41, -v239
  v_fma_f32 v135, v135, s41, -v239
  v_fma_f32 v136, v136, s41, -v239
  v_fma_f32 v137, v137, s41, -v239
  v_fma_f32 v138, v138, s41, -v239
  v_fma_f32 v139, v139, s41, -v239
  v_fma_f32 v140, v140, s41, -v239
  v_fma_f32 v141, v141, s41, -v239
  v_fma_f32 v142, v142, s41, -v239
  v_fma_f32 v143, v143, s41, -v239
  v_exp_f32 v128, v128
  v_exp_f32 v129, v129
  v_add_f32 v241, v112, v113
  v_cvt_pk_bf16_f32 v144, v112, v113
  v_add_f32 v240, v240, v241
  v_exp_f32 v130, v130
  v_exp_f32 v131, v131
  v_add_f32 v243, v114, v115
  v_cvt_pk_bf16_f32 v145, v114, v115
  v_add_f32 v240, v240, v243
  v_exp_f32 v132, v132
  v_exp_f32 v133, v133
  v_add_f32 v241, v116, v117
  v_cvt_pk_bf16_f32 v146, v116, v117
  v_add_f32 v240, v240, v241
  v_exp_f32 v134, v134
  v_exp_f32 v135, v135
  v_add_f32 v243, v118, v119
  v_cvt_pk_bf16_f32 v147, v118, v119
  v_add_f32 v240, v240, v243
  v_exp_f32 v136, v136
  v_exp_f32 v137, v137
  v_add_f32 v241, v120, v121
  v_cvt_pk_bf16_f32 v148, v120, v121
  v_add_f32 v240, v240, v241
  v_exp_f32 v138, v138
  v_exp_f32 v139, v139
  v_add_f32 v243, v122, v123
  v_cvt_pk_bf16_f32 v149, v122, v123
  v_add_f32 v240, v240, v243
  v_exp_f32 v140, v140
  v_exp_f32 v141, v141
  v_add_f32 v241, v124, v125
  v_cvt_pk_bf16_f32 v150, v124, v125
  v_add_f32 v240, v240, v241
  v_exp_f32 v142, v142
  v_exp_f32 v143, v143
  v_add_f32 v243, v126, v127
  v_cvt_pk_bf16_f32 v151, v126, v127
  v_add_f32 v240, v240, v243
  v_add_f32 v241, v128, v129
  v_cvt_pk_bf16_f32 v152, v128, v129
  v_add_f32 v240, v240, v241
  v_add_f32 v243, v130, v131
  v_cvt_pk_bf16_f32 v153, v130, v131
  v_add_f32 v240, v240, v243
  v_add_f32 v241, v132, v133
  v_cvt_pk_bf16_f32 v154, v132, v133
  v_add_f32 v240, v240, v241
  v_add_f32 v243, v134, v135
  v_cvt_pk_bf16_f32 v155, v134, v135
  v_add_f32 v240, v240, v243
  v_add_f32 v241, v136, v137
  v_cvt_pk_bf16_f32 v156, v136, v137
  v_add_f32 v240, v240, v241
  v_add_f32 v243, v138, v139
  v_cvt_pk_bf16_f32 v157, v138, v139
  v_add_f32 v240, v240, v243
  v_add_f32 v241, v140, v141
  v_cvt_pk_bf16_f32 v158, v140, v141
  v_add_f32 v240, v240, v241
  v_add_f32 v243, v142, v143
  v_cvt_pk_bf16_f32 v159, v142, v143
  v_add_f32 v240, v240, v243
  s_waitcnt vmcnt(8)
  s_barrier
  s_add_u32 s38, s37, 32768
  s_mov_b32 m0, s38
  s_mov_b32 s39, 98304
  buffer_load_dwordx4 v236, s[28:31], s39 offen nt lds
  buffer_load_dwordx4 v237, s[28:31], s39 offen offset:1024 nt lds
  s_add_u32 s38, s37, 65536
  s_mov_b32 m0, s38
  s_mov_b32 s39, 65536
  buffer_load_dwordx4 v238, s[32:35], s39 offen nt lds
  buffer_load_dwordx4 v238, s[32:35], s39 offen offset:1024 nt lds
  s_setprio 1
  ds_read_b128 v[48:51], v224 offset:49152
  ds_read_b128 v[52:55], v225 offset:49152
  ds_read_b128 v[56:59], v226 offset:49152
  ds_read_b128 v[60:63], v227 offset:49152
  ds_read_b128 v[64:67], v228 offset:49152
  ds_read_b128 v[68:71], v229 offset:49152
  ds_read_b128 v[72:75], v230 offset:49152
  ds_read_b128 v[76:79], v231 offset:49152
  s_waitcnt lgkmcnt(7)
  v_mfma_f32_32x32x16_bf16 v[112:127], v[48:51], v[16:19], 0
  ds_read_b128 v[48:51], v224 offset:57344
  s_waitcnt lgkmcnt(7)
  v_mfma_f32_32x32x16_bf16 v[112:127], v[52:55], v[20:23], v[112:127]
  ds_read_b128 v[52:55], v225 offset:57344
  s_waitcnt lgkmcnt(7)
  v_mfma_f32_32x32x16_bf16 v[112:127], v[56:59], v[24:27], v[112:127]
  ds_read_b128 v[56:59], v226 offset:57344
  s_waitcnt lgkmcnt(7)
  v_mfma_f32_32x32x16_bf16 v[112:127], v[60:63], v[28:31], v[112:127]
  ds_read_b128 v[60:63], v227 offset:57344
  s_waitcnt lgkmcnt(7)
  v_mfma_f32_32x32x16_bf16 v[112:127], v[64:67], v[32:35], v[112:127]
  ds_read_b128 v[64:67], v228 offset:57344
  s_waitcnt lgkmcnt(7)
  v_mfma_f32_32x32x16_bf16 v[112:127], v[68:71], v[36:39], v[112:127]
  ds_read_b128 v[68:71], v229 offset:57344
  s_waitcnt lgkmcnt(7)
  v_mfma_f32_32x32x16_bf16 v[112:127], v[72:75], v[40:43], v[112:127]
  ds_read_b128 v[72:75], v230 offset:57344
  s_waitcnt lgkmcnt(7)
  v_mfma_f32_32x32x16_bf16 v[112:127], v[76:79], v[44:47], v[112:127]
  ds_read_b128 v[76:79], v231 offset:57344
  s_waitcnt lgkmcnt(7)
  v_mfma_f32_32x32x16_bf16 v[128:143], v[48:51], v[16:19], 0
  ds_read_b64_tr_b16 v[80:81], v232 offset:16384
  ds_read_b64_tr_b16 v[82:83], v232 offset:18432
  s_waitcnt lgkmcnt(8)
  v_mfma_f32_32x32x16_bf16 v[128:143], v[52:55], v[20:23], v[128:143]
  ds_read_b64_tr_b16 v[84:85], v233 offset:16384
  ds_read_b64_tr_b16 v[86:87], v233 offset:18432
  s_waitcnt lgkmcnt(9)
  v_mfma_f32_32x32x16_bf16 v[128:143], v[56:59], v[24:27], v[128:143]
  ds_read_b64_tr_b16 v[88:89], v234 offset:16384
  ds_read_b64_tr_b16 v[90:91], v234 offset:18432
  s_waitcnt lgkmcnt(10)
  v_mfma_f32_32x32x16_bf16 v[128:143], v[60:63], v[28:31], v[128:143]
  ds_read_b64_tr_b16 v[92:93], v235 offset:16384
  ds_read_b64_tr_b16 v[94:95], v235 offset:18432
  s_waitcnt lgkmcnt(11)
  v_mfma_f32_32x32x16_bf16 v[128:143], v[64:67], v[32:35], v[128:143]
  ds_read_b64_tr_b16 v[96:97], v232 offset:20480
  ds_read_b64_tr_b16 v[98:99], v232 offset:22528
  s_waitcnt lgkmcnt(12)
  v_mfma_f32_32x32x16_bf16 v[128:143], v[68:71], v[36:39], v[128:143]
  ds_read_b64_tr_b16 v[100:101], v233 offset:20480
  ds_read_b64_tr_b16 v[102:103], v233 offset:22528
  s_waitcnt lgkmcnt(13)
  v_mfma_f32_32x32x16_bf16 v[128:143], v[72:75], v[40:43], v[128:143]
  ds_read_b64_tr_b16 v[104:105], v234 offset:20480
  ds_read_b64_tr_b16 v[106:107], v234 offset:22528
  s_waitcnt lgkmcnt(13)
  v_mfma_f32_32x32x16_bf16 v[128:143], v[76:79], v[44:47], v[128:143]
  ds_read_b64_tr_b16 v[108:109], v235 offset:20480
  ds_read_b64_tr_b16 v[110:111], v235 offset:22528
  s_waitcnt lgkmcnt(8)
  v_mfma_f32_32x32x16_bf16 v[160:175], v[80:83], v[144:147], v[160:175]
  v_mfma_f32_32x32x16_bf16 v[176:191], v[84:87], v[144:147], v[176:191]
  v_mfma_f32_32x32x16_bf16 v[192:207], v[88:91], v[144:147], v[192:207]
  v_mfma_f32_32x32x16_bf16 v[208:223], v[92:95], v[144:147], v[208:223]
  ds_read_b64_tr_b16 v[80:81], v232 offset:24576
  ds_read_b64_tr_b16 v[82:83], v232 offset:26624
  ds_read_b64_tr_b16 v[84:85], v233 offset:24576
  ds_read_b64_tr_b16 v[86:87], v233 offset:26624
  ds_read_b64_tr_b16 v[88:89], v234 offset:24576
  ds_read_b64_tr_b16 v[90:91], v234 offset:26624
  ds_read_b64_tr_b16 v[92:93], v235 offset:24576
  ds_read_b64_tr_b16 v[94:95], v235 offset:26624
  s_waitcnt lgkmcnt(8)
  v_mfma_f32_32x32x16_bf16 v[160:175], v[96:99], v[148:151], v[160:175]
  v_mfma_f32_32x32x16_bf16 v[176:191], v[100:103], v[148:151], v[176:191]
  v_mfma_f32_32x32x16_bf16 v[192:207], v[104:107], v[148:151], v[192:207]
  v_mfma_f32_32x32x16_bf16 v[208:223], v[108:111], v[148:151], v[208:223]
  ds_read_b64_tr_b16 v[96:97], v232 offset:28672
  ds_read_b64_tr_b16 v[98:99], v232 offset:30720
  ds_read_b64_tr_b16 v[100:101], v233 offset:28672
  ds_read_b64_tr_b16 v[102:103], v233 offset:30720
  ds_read_b64_tr_b16 v[104:105], v234 offset:28672
  ds_read_b64_tr_b16 v[106:107], v234 offset:30720
  ds_read_b64_tr_b16 v[108:109], v235 offset:28672
  ds_read_b64_tr_b16 v[110:111], v235 offset:30720
  s_waitcnt lgkmcnt(8)
  v_mfma_f32_32x32x16_bf16 v[160:175], v[80:83], v[152:155], v[160:175]
  v_mfma_f32_32x32x16_bf16 v[176:191], v[84:87], v[152:155], v[176:191]
  v_mfma_f32_32x32x16_bf16 v[192:207], v[88:91], v[152:155], v[192:207]
  v_mfma_f32_32x32x16_bf16 v[208:223], v[92:95], v[152:155], v[208:223]
  s_waitcnt lgkmcnt(0)
  v_mfma_f32_32x32x16_bf16 v[160:175], v[96:99], v[156:159], v[160:175]
  v_mfma_f32_32x32x16_bf16 v[176:191], v[100:103], v[156:159], v[176:191]
  v_mfma_f32_32x32x16_bf16 v[192:207], v[104:107], v[156:159], v[192:207]
  v_mfma_f32_32x32x16_bf16 v[208:223], v[108:111], v[156:159], v[208:223]
  s_setprio 0
  s_waitcnt vmcnt(8)
  s_barrier
  s_add_u32 s38, s37, 49152
  s_mov_b32 m0, s38
  s_mov_b32 s39, 114688
  buffer_load_dwordx4 v236, s[28:31], s39 offen nt lds
  buffer_load_dwordx4 v237, s[28:31], s39 offen offset:1024 nt lds
  s_add_u32 s38, s37, 81920
  s_mov_b32 m0, s38
  s_mov_b32 s39, 81920
  buffer_load_dwordx4 v238, s[32:35], s39 offen nt lds
  buffer_load_dwordx4 v238, s[32:35], s39 offen offset:1024 nt lds
  v_max3_f32 v241, v112, v113, v114
  v_max3_f32 v242, v115, v116, v117
  v_max3_f32 v243, v118, v119, v120
  v_max3_f32 v244, v121, v122, v123
  v_max3_f32 v245, v124, v125, v126
  v_max3_f32 v241, v241, v242, v127
  v_max3_f32 v243, v243, v244, v245
  v_max3_f32 v242, v128, v129, v130
  v_max3_f32 v244, v131, v132, v133
  v_max3_f32 v245, v134, v135, v136
  v_max3_f32 v246, v137, v138, v139
  v_max3_f32 v247, v140, v141, v142
  v_max3_f32 v241, v241, v243, v143
  v_max3_f32 v242, v242, v244, v245
  v_max3_f32 v241, v241, v246, v247
  v_max_f32 v241, v241, v242
  v_mov_b32 v242, v241
  v_add_f32 v243, s57, v239
  s_nop 0
  v_permlane32_swap_b32 v241, v242
  v_max_f32 v241, v241, v242
  v_mul_f32 v241, s41, v241
  v_cmp_gt_f32 vcc, v241, v243
  s_nop 1
  s_cbranch_vccz L_skip_b1
  v_max_f32 v241, v239, v241
  v_sub_f32 v242, v239, v241
  v_exp_f32 v242, v242
  v_mov_b32 v239, v241
  v_mul_f32 v160, v242, v160
  v_mul_f32 v161, v242, v161
  v_mul_f32 v162, v242, v162
  v_mul_f32 v163, v242, v163
  v_mul_f32 v164, v242, v164
  v_mul_f32 v165, v242, v165
  v_mul_f32 v166, v242, v166
  v_mul_f32 v167, v242, v167
  v_mul_f32 v168, v242, v168
  v_mul_f32 v169, v242, v169
  v_mul_f32 v170, v242, v170
  v_mul_f32 v171, v242, v171
  v_mul_f32 v172, v242, v172
  v_mul_f32 v173, v242, v173
  v_mul_f32 v174, v242, v174
  v_mul_f32 v175, v242, v175
  v_mul_f32 v176, v242, v176
  v_mul_f32 v177, v242, v177
  v_mul_f32 v178, v242, v178
  v_mul_f32 v179, v242, v179
  v_mul_f32 v180, v242, v180
  v_mul_f32 v181, v242, v181
  v_mul_f32 v182, v242, v182
  v_mul_f32 v183, v242, v183
  v_mul_f32 v184, v242, v184
  v_mul_f32 v185, v242, v185
  v_mul_f32 v186, v242, v186
  v_mul_f32 v187, v242, v187
  v_mul_f32 v188, v242, v188
  v_mul_f32 v189, v242, v189
  v_mul_f32 v190, v242, v190
  v_mul_f32 v191, v242, v191
  v_mul_f32 v192, v242, v192
  v_mul_f32 v193, v242, v193
  v_mul_f32 v194, v242, v194
  v_mul_f32 v195, v242, v195
  v_mul_f32 v196, v242, v196
  v_mul_f32 v197, v242, v197
  v_mul_f32 v198, v242, v198
  v_mul_f32 v199, v242, v199
  v_mul_f32 v200, v242, v200
  v_mul_f32 v201, v242, v201
  v_mul_f32 v202, v242, v202
  v_mul_f32 v203, v242, v203
  v_mul_f32 v204, v242, v204
  v_mul_f32 v205, v242, v205
  v_mul_f32 v206, v242, v206
  v_mul_f32 v207, v242, v207
  v_mul_f32 v208, v242, v208
  v_mul_f32 v209, v242, v209
  v_mul_f32 v210, v242, v210
  v_mul_f32 v211, v242, v211
  v_mul_f32 v212, v242, v212
  v_mul_f32 v213, v242, v213
  v_mul_f32 v214, v242, v214
  v_mul_f32 v215, v242, v215
  v_mul_f32 v216, v242, v216
  v_mul_f32 v217, v242, v217
  v_mul_f32 v218, v242, v218
  v_mul_f32 v219, v242, v219
  v_mul_f32 v220, v242, v220
  v_mul_f32 v221, v242, v221
  v_mul_f32 v222, v242, v222
  v_mul_f32 v223, v242, v223
  v_mul_f32 v240, v242, v240
L_skip_b1:
  v_fma_f32 v112, v112, s41, -v239
  v_fma_f32 v113, v113, s41, -v239
  v_fma_f32 v114, v114, s41, -v239
  v_fma_f32 v115, v115, s41, -v239
  v_fma_f32 v116, v116, s41, -v239
  v_fma_f32 v117, v117, s41, -v239
  v_fma_f32 v118, v118, s41, -v239
  v_fma_f32 v119, v119, s41, -v239
  v_fma_f32 v120, v120, s41, -v239
  v_fma_f32 v121, v121, s41, -v239
  v_fma_f32 v122, v122, s41, -v239
  v_fma_f32 v123, v123, s41, -v239
  v_fma_f32 v124, v124, s41, -v239
  v_fma_f32 v125, v125, s41, -v239
  v_fma_f32 v126, v126, s41, -v239
  v_fma_f32 v127, v127, s41, -v239
  v_exp_f32 v112, v112
  v_exp_f32 v113, v113
  v_exp_f32 v114, v114
  v_exp_f32 v115, v115
  v_exp_f32 v116, v116
  v_exp_f32 v117, v117
  v_exp_f32 v118, v118
  v_exp_f32 v119, v119
  v_exp_f32 v120, v120
  v_exp_f32 v121, v121
  v_exp_f32 v122, v122
  v_exp_f32 v123, v123
  v_exp_f32 v124, v124
  v_exp_f32 v125, v125
  v_exp_f32 v126, v126
  v_exp_f32 v127, v127
  v_fma_f32 v128, v128, s41, -v239
  v_fma_f32 v129, v129, s41, -v239
  v_fma_f32 v130, v130, s41, -v239
  v_fma_f32 v131, v131, s41, -v239
  v_fma_f32 v132, v132, s41, -v239
  v_fma_f32 v133, v133, s41, -v239
  v_fma_f32 v134, v134, s41, -v239
  v_fma_f32 v135, v135, s41, -v239
  v_fma_f32 v136, v136, s41, -v239
  v_fma_f32 v137, v137, s41, -v239
  v_fma_f32 v138, v138, s41, -v239
  v_fma_f32 v139, v139, s41, -v239
  v_fma_f32 v140, v140, s41, -v239
  v_fma_f32 v141, v141, s41, -v239
  v_fma_f32 v142, v142, s41, -v239
  v_fma_f32 v143, v143, s41, -v239
  v_exp_f32 v128, v128
  v_exp_f32 v129, v129
  v_add_f32 v241, v112, v113
  v_cvt_pk_bf16_f32 v144, v112, v113
  v_add_f32 v240, v240, v241
  v_exp_f32 v130, v130
  v_exp_f32 v131, v131
  v_add_f32 v243, v114, v115
  v_cvt_pk_bf16_f32 v145, v114, v115
  v_add_f32 v240, v240, v243
  v_exp_f32 v132, v132
  v_exp_f32 v133, v133
  v_add_f32 v241, v116, v117
  v_cvt_pk_bf16_f32 v146, v116, v117
  v_add_f32 v240, v240, v241
  v_exp_f32 v134, v134
  v_exp_f32 v135, v135
  v_add_f32 v243, v118, v119
  v_cvt_pk_bf16_f32 v147, v118, v119
  v_add_f32 v240, v240, v243
  v_exp_f32 v136, v136
  v_exp_f32 v137, v137
  v_add_f32 v241, v120, v121
  v_cvt_pk_bf16_f32 v148, v120, v121
  v_add_f32 v240, v240, v241
  v_exp_f32 v138, v138
  v_exp_f32 v139, v139
  v_add_f32 v243, v122, v123
  v_cvt_pk_bf16_f32 v149, v122, v123
  v_add_f32 v240, v240, v243
  v_exp_f32 v140, v140
  v_exp_f32 v141, v141
  v_add_f32 v241, v124, v125
  v_cvt_pk_bf16_f32 v150, v124, v125
  v_add_f32 v240, v240, v241
  v_exp_f32 v142, v142
  v_exp_f32 v143, v143
  v_add_f32 v243, v126, v127
  v_cvt_pk_bf16_f32 v151, v126, v127
  v_add_f32 v240, v240, v243
  v_add_f32 v241, v128, v129
  v_cvt_pk_bf16_f32 v152, v128, v129
  v_add_f32 v240, v240, v241
  v_add_f32 v243, v130, v131
  v_cvt_pk_bf16_f32 v153, v130, v131
  v_add_f32 v240, v240, v243
  v_add_f32 v241, v132, v133
  v_cvt_pk_bf16_f32 v154, v132, v133
  v_add_f32 v240, v240, v241
  v_add_f32 v243, v134, v135
  v_cvt_pk_bf16_f32 v155, v134, v135
  v_add_f32 v240, v240, v243
  v_add_f32 v241, v136, v137
  v_cvt_pk_bf16_f32 v156, v136, v137
  v_add_f32 v240, v240, v241
  v_add_f32 v243, v138, v139
  v_cvt_pk_bf16_f32 v157, v138, v139
  v_add_f32 v240, v240, v243
  v_add_f32 v241, v140, v141
  v_cvt_pk_bf16_f32 v158, v140, v141
  v_add_f32 v240, v240, v241
  v_add_f32 v243, v142, v143
  v_cvt_pk_bf16_f32 v159, v142, v143
  v_add_f32 v240, v240, v243
  s_waitcnt vmcnt(8)
  s_barrier
  s_add_u32 s38, s37, 98304
  s_mov_b32 m0, s38
  s_mov_b32 s39, 98304
  buffer_load_dwordx4 v238, s[32:35], s39 offen nt lds
  buffer_load_dwordx4 v238, s[32:35], s39 offen offset:1024 nt lds
  s_setprio 1
  ds_read_b128 v[48:51], v224 offset:16384
  ds_read_b128 v[52:55], v225 offset:16384
  ds_read_b128 v[56:59], v226 offset:16384
  ds_read_b128 v[60:63], v227 offset:16384
  ds_read_b128 v[64:67], v228 offset:16384
  ds_read_b128 v[68:71], v229 offset:16384
  ds_read_b128 v[72:75], v230 offset:16384
  ds_read_b128 v[76:79], v231 offset:16384
  s_waitcnt lgkmcnt(7)
  v_mfma_f32_32x32x16_bf16 v[112:127], v[48:51], v[16:19], 0
  ds_read_b128 v[48:51], v224 offset:24576
  s_waitcnt lgkmcnt(7)
  v_mfma_f32_32x32x16_bf16 v[112:127], v[52:55], v[20:23], v[112:127]
  ds_read_b128 v[52:55], v225 offset:24576
  s_waitcnt lgkmcnt(7)
  v_mfma_f32_32x32x16_bf16 v[112:127], v[56:59], v[24:27], v[112:127]
  ds_read_b128 v[56:59], v226 offset:24576
  s_waitcnt lgkmcnt(7)
  v_mfma_f32_32x32x16_bf16 v[112:127], v[60:63], v[28:31], v[112:127]
  ds_read_b128 v[60:63], v227 offset:24576
  s_waitcnt lgkmcnt(7)
  v_mfma_f32_32x32x16_bf16 v[112:127], v[64:67], v[32:35], v[112:127]
  ds_read_b128 v[64:67], v228 offset:24576
  s_waitcnt lgkmcnt(7)
  v_mfma_f32_32x32x16_bf16 v[112:127], v[68:71], v[36:39], v[112:127]
  ds_read_b128 v[68:71], v229 offset:24576
  s_waitcnt lgkmcnt(7)
  v_mfma_f32_32x32x16_bf16 v[112:127], v[72:75], v[40:43], v[112:127]
  ds_read_b128 v[72:75], v230 offset:24576
  s_waitcnt lgkmcnt(7)
  v_mfma_f32_32x32x16_bf16 v[112:127], v[76:79], v[44:47], v[112:127]
  ds_read_b128 v[76:79], v231 offset:24576
  s_waitcnt lgkmcnt(7)
  v_mfma_f32_32x32x16_bf16 v[128:143], v[48:51], v[16:19], 0
  ds_read_b64_tr_b16 v[80:81], v232 offset:49152
  ds_read_b64_tr_b16 v[82:83], v232 offset:51200
  s_waitcnt lgkmcnt(8)
  v_mfma_f32_32x32x16_bf16 v[128:143], v[52:55], v[20:23], v[128:143]
  ds_read_b64_tr_b16 v[84:85], v233 offset:49152
  ds_read_b64_tr_b16 v[86:87], v233 offset:51200
  s_waitcnt lgkmcnt(9)
  v_mfma_f32_32x32x16_bf16 v[128:143], v[56:59], v[24:27], v[128:143]
  ds_read_b64_tr_b16 v[88:89], v234 offset:49152
  ds_read_b64_tr_b16 v[90:91], v234 offset:51200
  s_waitcnt lgkmcnt(10)
  v_mfma_f32_32x32x16_bf16 v[128:143], v[60:63], v[28:31], v[128:143]
  ds_read_b64_tr_b16 v[92:93], v235 offset:49152
  ds_read_b64_tr_b16 v[94:95], v235 offset:51200
  s_waitcnt lgkmcnt(11)
  v_mfma_f32_32x32x16_bf16 v[128:143], v[64:67], v[32:35], v[128:143]
  ds_read_b64_tr_b16 v[96:97], v232 offset:53248
  ds_read_b64_tr_b16 v[98:99], v232 offset:55296
  s_waitcnt lgkmcnt(12)
  v_mfma_f32_32x32x16_bf16 v[128:143], v[68:71], v[36:39], v[128:143]
  ds_read_b64_tr_b16 v[100:101], v233 offset:53248
  ds_read_b64_tr_b16 v[102:103], v233 offset:55296
  s_waitcnt lgkmcnt(13)
  v_mfma_f32_32x32x16_bf16 v[128:143], v[72:75], v[40:43], v[128:143]
  ds_read_b64_tr_b16 v[104:105], v234 offset:53248
  ds_read_b64_tr_b16 v[106:107], v234 offset:55296
  s_waitcnt lgkmcnt(13)
  v_mfma_f32_32x32x16_bf16 v[128:143], v[76:79], v[44:47], v[128:143]
  ds_read_b64_tr_b16 v[108:109], v235 offset:53248
  ds_read_b64_tr_b16 v[110:111], v235 offset:55296
  s_waitcnt lgkmcnt(8)
  v_mfma_f32_32x32x16_bf16 v[160:175], v[80:83], v[144:147], v[160:175]
  v_mfma_f32_32x32x16_bf16 v[176:191], v[84:87], v[144:147], v[176:191]
  v_mfma_f32_32x32x16_bf16 v[192:207], v[88:91], v[144:147], v[192:207]
  v_mfma_f32_32x32x16_bf16 v[208:223], v[92:95], v[144:147], v[208:223]
  ds_read_b64_tr_b16 v[80:81], v232 offset:57344
  ds_read_b64_tr_b16 v[82:83], v232 offset:59392
  ds_read_b64_tr_b16 v[84:85], v233 offset:57344
  ds_read_b64_tr_b16 v[86:87], v233 offset:59392
  ds_read_b64_tr_b16 v[88:89], v234 offset:57344
  ds_read_b64_tr_b16 v[90:91], v234 offset:59392
  ds_read_b64_tr_b16 v[92:93], v235 offset:57344
  ds_read_b64_tr_b16 v[94:95], v235 offset:59392
  s_waitcnt lgkmcnt(8)
  v_mfma_f32_32x32x16_bf16 v[160:175], v[96:99], v[148:151], v[160:175]
  v_mfma_f32_32x32x16_bf16 v[176:191], v[100:103], v[148:151], v[176:191]
  v_mfma_f32_32x32x16_bf16 v[192:207], v[104:107], v[148:151], v[192:207]
  v_mfma_f32_32x32x16_bf16 v[208:223], v[108:111], v[148:151], v[208:223]
  ds_read_b64_tr_b16 v[96:97], v232 offset:61440
  ds_read_b64_tr_b16 v[98:99], v232 offset:63488
  ds_read_b64_tr_b16 v[100:101], v233 offset:61440
  ds_read_b64_tr_b16 v[102:103], v233 offset:63488
  ds_read_b64_tr_b16 v[104:105], v234 offset:61440
  ds_read_b64_tr_b16 v[106:107], v234 offset:63488
  ds_read_b64_tr_b16 v[108:109], v235 offset:61440
  ds_read_b64_tr_b16 v[110:111], v235 offset:63488
  s_waitcnt lgkmcnt(8)
  v_mfma_f32_32x32x16_bf16 v[160:175], v[80:83], v[152:155], v[160:175]
  v_mfma_f32_32x32x16_bf16 v[176:191], v[84:87], v[152:155], v[176:191]
  v_mfma_f32_32x32x16_bf16 v[192:207], v[88:91], v[152:155], v[192:207]
  v_mfma_f32_32x32x16_bf16 v[208:223], v[92:95], v[152:155], v[208:223]
  s_waitcnt lgkmcnt(0)
  v_mfma_f32_32x32x16_bf16 v[160:175], v[96:99], v[156:159], v[160:175]
  v_mfma_f32_32x32x16_bf16 v[176:191], v[100:103], v[156:159], v[176:191]
  v_mfma_f32_32x32x16_bf16 v[192:207], v[104:107], v[156:159], v[192:207]
  v_mfma_f32_32x32x16_bf16 v[208:223], v[108:111], v[156:159], v[208:223]
  s_setprio 0
  s_waitcnt vmcnt(6)
  s_barrier
  s_add_u32 s38, s37, 114688
  s_mov_b32 m0, s38
  s_mov_b32 s39, 114688
  buffer_load_dwordx4 v238, s[32:35], s39 offen nt lds
  buffer_load_dwordx4 v238, s[32:35], s39 offen offset:1024 nt lds
  v_max3_f32 v241, v112, v113, v114
  v_max3_f32 v242, v115, v116, v117
  v_max3_f32 v243, v118, v119, v120
  v_max3_f32 v244, v121, v122, v123
  v_max3_f32 v245, v124, v125, v126
  v_max3_f32 v241, v241, v242, v127
  v_max3_f32 v243, v243, v244, v245
  v_max3_f32 v242, v128, v129, v130
  v_max3_f32 v244, v131, v132, v133
  v_max3_f32 v245, v134, v135, v136
  v_max3_f32 v246, v137, v138, v139
  v_max3_f32 v247, v140, v141, v142
  v_max3_f32 v241, v241, v243, v143
  v_max3_f32 v242, v242, v244, v245
  v_max3_f32 v241, v241, v246, v247
  v_max_f32 v241, v241, v242
  v_mov_b32 v242, v241
  v_add_f32 v243, s57, v239
  s_nop 0
  v_permlane32_swap_b32 v241, v242
  v_max_f32 v241, v241, v242
  v_mul_f32 v241, s41, v241
  v_cmp_gt_f32 vcc, v241, v243
  s_nop 1
  s_cbranch_vccz L_skip_b2
  v_max_f32 v241, v239, v241
  v_sub_f32 v242, v239, v241
  v_exp_f32 v242, v242
  v_mov_b32 v239, v241
  v_mul_f32 v160, v242, v160
  v_mul_f32 v161, v242, v161
  v_mul_f32 v162, v242, v162
  v_mul_f32 v163, v242, v163
  v_mul_f32 v164, v242, v164
  v_mul_f32 v165, v242, v165
  v_mul_f32 v166, v242, v166
  v_mul_f32 v167, v242, v167
  v_mul_f32 v168, v242, v168
  v_mul_f32 v169, v242, v169
  v_mul_f32 v170, v242, v170
  v_mul_f32 v171, v242, v171
  v_mul_f32 v172, v242, v172
  v_mul_f32 v173, v242, v173
  v_mul_f32 v174, v242, v174
  v_mul_f32 v175, v242, v175
  v_mul_f32 v176, v242, v176
  v_mul_f32 v177, v242, v177
  v_mul_f32 v178, v242, v178
  v_mul_f32 v179, v242, v179
  v_mul_f32 v180, v242, v180
  v_mul_f32 v181, v242, v181
  v_mul_f32 v182, v242, v182
  v_mul_f32 v183, v242, v183
  v_mul_f32 v184, v242, v184
  v_mul_f32 v185, v242, v185
  v_mul_f32 v186, v242, v186
  v_mul_f32 v187, v242, v187
  v_mul_f32 v188, v242, v188
  v_mul_f32 v189, v242, v189
  v_mul_f32 v190, v242, v190
  v_mul_f32 v191, v242, v191
  v_mul_f32 v192, v242, v192
  v_mul_f32 v193, v242, v193
  v_mul_f32 v194, v242, v194
  v_mul_f32 v195, v242, v195
  v_mul_f32 v196, v242, v196
  v_mul_f32 v197, v242, v197
  v_mul_f32 v198, v242, v198
  v_mul_f32 v199, v242, v199
  v_mul_f32 v200, v242, v200
  v_mul_f32 v201, v242, v201
  v_mul_f32 v202, v242, v202
  v_mul_f32 v203, v242, v203
  v_mul_f32 v204, v242, v204
  v_mul_f32 v205, v242, v205
  v_mul_f32 v206, v242, v206
  v_mul_f32 v207, v242, v207
  v_mul_f32 v208, v242, v208
  v_mul_f32 v209, v242, v209
  v_mul_f32 v210, v242, v210
  v_mul_f32 v211, v242, v211
  v_mul_f32 v212, v242, v212
  v_mul_f32 v213, v242, v213
  v_mul_f32 v214, v242, v214
  v_mul_f32 v215, v242, v215
  v_mul_f32 v216, v242, v216
  v_mul_f32 v217, v242, v217
  v_mul_f32 v218, v242, v218
  v_mul_f32 v219, v242, v219
  v_mul_f32 v220, v242, v220
  v_mul_f32 v221, v242, v221
  v_mul_f32 v222, v242, v222
  v_mul_f32 v223, v242, v223
  v_mul_f32 v240, v242, v240
L_skip_b2:
  v_fma_f32 v112, v112, s41, -v239
  v_fma_f32 v113, v113, s41, -v239
  v_fma_f32 v114, v114, s41, -v239
  v_fma_f32 v115, v115, s41, -v239
  v_fma_f32 v116, v116, s41, -v239
  v_fma_f32 v117, v117, s41, -v239
  v_fma_f32 v118, v118, s41, -v239
  v_fma_f32 v119, v119, s41, -v239
  v_fma_f32 v120, v120, s41, -v239
  v_fma_f32 v121, v121, s41, -v239
  v_fma_f32 v122, v122, s41, -v239
  v_fma_f32 v123, v123, s41, -v239
  v_fma_f32 v124, v124, s41, -v239
  v_fma_f32 v125, v125, s41, -v239
  v_fma_f32 v126, v126, s41, -v239
  v_fma_f32 v127, v127, s41, -v239
  v_exp_f32 v112, v112
  v_exp_f32 v113, v113
  v_exp_f32 v114, v114
  v_exp_f32 v115, v115
  v_exp_f32 v116, v116
  v_exp_f32 v117, v117
  v_exp_f32 v118, v118
  v_exp_f32 v119, v119
  v_exp_f32 v120, v120
  v_exp_f32 v121, v121
  v_exp_f32 v122, v122
  v_exp_f32 v123, v123
  v_exp_f32 v124, v124
  v_exp_f32 v125, v125
  v_exp_f32 v126, v126
  v_exp_f32 v127, v127
  v_fma_f32 v128, v128, s41, -v239
  v_fma_f32 v129, v129, s41, -v239
  v_fma_f32 v130, v130, s41, -v239
  v_fma_f32 v131, v131, s41, -v239
  v_fma_f32 v132, v132, s41, -v239
  v_fma_f32 v133, v133, s41, -v239
  v_fma_f32 v134, v134, s41, -v239
  v_fma_f32 v135, v135, s41, -v239
  v_fma_f32 v136, v136, s41, -v239
  v_fma_f32 v137, v137, s41, -v239
  v_fma_f32 v138, v138, s41, -v239
  v_fma_f32 v139, v139, s41, -v239
  v_fma_f32 v140, v140, s41, -v239
  v_fma_f32 v141, v141, s41, -v239
  v_fma_f32 v142, v142, s41, -v239
  v_fma_f32 v143, v143, s41, -v239
  v_exp_f32 v128, v128
  v_exp_f32 v129, v129
  v_add_f32 v241, v112, v113
  v_cvt_pk_bf16_f32 v144, v112, v113
  v_add_f32 v240, v240, v241
  v_exp_f32 v130, v130
  v_exp_f32 v131, v131
  v_add_f32 v243, v114, v115
  v_cvt_pk_bf16_f32 v145, v114, v115
  v_add_f32 v240, v240, v243
  v_exp_f32 v132, v132
  v_exp_f32 v133, v133
  v_add_f32 v241, v116, v117
  v_cvt_pk_bf16_f32 v146, v116, v117
  v_add_f32 v240, v240, v241
  v_exp_f32 v134, v134
  v_exp_f32 v135, v135
  v_add_f32 v243, v118, v119
  v_cvt_pk_bf16_f32 v147, v118, v119
  v_add_f32 v240, v240, v243
  v_exp_f32 v136, v136
  v_exp_f32 v137, v137
  v_add_f32 v241, v120, v121
  v_cvt_pk_bf16_f32 v148, v120, v121
  v_add_f32 v240, v240, v241
  v_exp_f32 v138, v138
  v_exp_f32 v139, v139
  v_add_f32 v243, v122, v123
  v_cvt_pk_bf16_f32 v149, v122, v123
  v_add_f32 v240, v240, v243
  v_exp_f32 v140, v140
  v_exp_f32 v141, v141
  v_add_f32 v241, v124, v125
  v_cvt_pk_bf16_f32 v150, v124, v125
  v_add_f32 v240, v240, v241
  v_exp_f32 v142, v142
  v_exp_f32 v143, v143
  v_add_f32 v243, v126, v127
  v_cvt_pk_bf16_f32 v151, v126, v127
  v_add_f32 v240, v240, v243
  v_add_f32 v241, v128, v129
  v_cvt_pk_bf16_f32 v152, v128, v129
  v_add_f32 v240, v240, v241
  v_add_f32 v243, v130, v131
  v_cvt_pk_bf16_f32 v153, v130, v131
  v_add_f32 v240, v240, v243
  v_add_f32 v241, v132, v133
  v_cvt_pk_bf16_f32 v154, v132, v133
  v_add_f32 v240, v240, v241
  v_add_f32 v243, v134, v135
  v_cvt_pk_bf16_f32 v155, v134, v135
  v_add_f32 v240, v240, v243
  v_add_f32 v241, v136, v137
  v_cvt_pk_bf16_f32 v156, v136, v137
  v_add_f32 v240, v240, v241
  v_add_f32 v243, v138, v139
  v_cvt_pk_bf16_f32 v157, v138, v139
  v_add_f32 v240, v240, v243
  v_add_f32 v241, v140, v141
  v_cvt_pk_bf16_f32 v158, v140, v141
  v_add_f32 v240, v240, v241
  v_add_f32 v243, v142, v143
  v_cvt_pk_bf16_f32 v159, v142, v143
  v_add_f32 v240, v240, v243
  s_waitcnt vmcnt(4)
  s_barrier
  s_setprio 1
  ds_read_b128 v[48:51], v224 offset:49152
  ds_read_b128 v[52:55], v225 offset:49152
  ds_read_b128 v[56:59], v226 offset:49152
  ds_read_b128 v[60:63], v227 offset:49152
  ds_read_b128 v[64:67], v228 offset:49152
  ds_read_b128 v[68:71], v229 offset:49152
  ds_read_b128 v[72:75], v230 offset:49152
  ds_read_b128 v[76:79], v231 offset:49152
  s_waitcnt lgkmcnt(7)
  v_mfma_f32_32x32x16_bf16 v[112:127], v[48:51], v[16:19], 0
  ds_read_b128 v[48:51], v224 offset:57344
  s_waitcnt lgkmcnt(7)
  v_mfma_f32_32x32x16_bf16 v[112:127], v[52:55], v[20:23], v[112:127]
  ds_read_b128 v[52:55], v225 offset:57344
  s_waitcnt lgkmcnt(7)
  v_mfma_f32_32x32x16_bf16 v[112:127], v[56:59], v[24:27], v[112:127]
  ds_read_b128 v[56:59], v226 offset:57344
  s_waitcnt lgkmcnt(7)
  v_mfma_f32_32x32x16_bf16 v[112:127], v[60:63], v[28:31], v[112:127]
  ds_read_b128 v[60:63], v227 offset:57344
  s_waitcnt lgkmcnt(7)
  v_mfma_f32_32x32x16_bf16 v[112:127], v[64:67], v[32:35], v[112:127]
  ds_read_b128 v[64:67], v228 offset:57344
  s_waitcnt lgkmcnt(7)
  v_mfma_f32_32x32x16_bf16 v[112:127], v[68:71], v[36:39], v[112:127]
  ds_read_b128 v[68:71], v229 offset:57344
  s_waitcnt lgkmcnt(7)
  v_mfma_f32_32x32x16_bf16 v[112:127], v[72:75], v[40:43], v[112:127]
  ds_read_b128 v[72:75], v230 offset:57344
  s_waitcnt lgkmcnt(7)
  v_mfma_f32_32x32x16_bf16 v[112:127], v[76:79], v[44:47], v[112:127]
  ds_read_b128 v[76:79], v231 offset:57344
  s_waitcnt lgkmcnt(7)
  v_mfma_f32_32x32x16_bf16 v[128:143], v[48:51], v[16:19], 0
  ds_read_b64_tr_b16 v[80:81], v232 offset:16384
  ds_read_b64_tr_b16 v[82:83], v232 offset:18432
  s_waitcnt lgkmcnt(8)
  v_mfma_f32_32x32x16_bf16 v[128:143], v[52:55], v[20:23], v[128:143]
  ds_read_b64_tr_b16 v[84:85], v233 offset:16384
  ds_read_b64_tr_b16 v[86:87], v233 offset:18432
  s_waitcnt lgkmcnt(9)
  v_mfma_f32_32x32x16_bf16 v[128:143], v[56:59], v[24:27], v[128:143]
  ds_read_b64_tr_b16 v[88:89], v234 offset:16384
  ds_read_b64_tr_b16 v[90:91], v234 offset:18432
  s_waitcnt lgkmcnt(10)
  v_mfma_f32_32x32x16_bf16 v[128:143], v[60:63], v[28:31], v[128:143]
  ds_read_b64_tr_b16 v[92:93], v235 offset:16384
  ds_read_b64_tr_b16 v[94:95], v235 offset:18432
  s_waitcnt lgkmcnt(11)
  v_mfma_f32_32x32x16_bf16 v[128:143], v[64:67], v[32:35], v[128:143]
  ds_read_b64_tr_b16 v[96:97], v232 offset:20480
  ds_read_b64_tr_b16 v[98:99], v232 offset:22528
  s_waitcnt lgkmcnt(12)
  v_mfma_f32_32x32x16_bf16 v[128:143], v[68:71], v[36:39], v[128:143]
  ds_read_b64_tr_b16 v[100:101], v233 offset:20480
  ds_read_b64_tr_b16 v[102:103], v233 offset:22528
  s_waitcnt lgkmcnt(13)
  v_mfma_f32_32x32x16_bf16 v[128:143], v[72:75], v[40:43], v[128:143]
  ds_read_b64_tr_b16 v[104:105], v234 offset:20480
  ds_read_b64_tr_b16 v[106:107], v234 offset:22528
  s_waitcnt lgkmcnt(13)
  v_mfma_f32_32x32x16_bf16 v[128:143], v[76:79], v[44:47], v[128:143]
  ds_read_b64_tr_b16 v[108:109], v235 offset:20480
  ds_read_b64_tr_b16 v[110:111], v235 offset:22528
  s_waitcnt lgkmcnt(8)
  v_mfma_f32_32x32x16_bf16 v[160:175], v[80:83], v[144:147], v[160:175]
  v_mfma_f32_32x32x16_bf16 v[176:191], v[84:87], v[144:147], v[176:191]
  v_mfma_f32_32x32x16_bf16 v[192:207], v[88:91], v[144:147], v[192:207]
  v_mfma_f32_32x32x16_bf16 v[208:223], v[92:95], v[144:147], v[208:223]
  ds_read_b64_tr_b16 v[80:81], v232 offset:24576
  ds_read_b64_tr_b16 v[82:83], v232 offset:26624
  ds_read_b64_tr_b16 v[84:85], v233 offset:24576
  ds_read_b64_tr_b16 v[86:87], v233 offset:26624
  ds_read_b64_tr_b16 v[88:89], v234 offset:24576
  ds_read_b64_tr_b16 v[90:91], v234 offset:26624
  ds_read_b64_tr_b16 v[92:93], v235 offset:24576
  ds_read_b64_tr_b16 v[94:95], v235 offset:26624
  s_waitcnt lgkmcnt(8)
  v_mfma_f32_32x32x16_bf16 v[160:175], v[96:99], v[148:151], v[160:175]
  v_mfma_f32_32x32x16_bf16 v[176:191], v[100:103], v[148:151], v[176:191]
  v_mfma_f32_32x32x16_bf16 v[192:207], v[104:107], v[148:151], v[192:207]
  v_mfma_f32_32x32x16_bf16 v[208:223], v[108:111], v[148:151], v[208:223]
  ds_read_b64_tr_b16 v[96:97], v232 offset:28672
  ds_read_b64_tr_b16 v[98:99], v232 offset:30720
  ds_read_b64_tr_b16 v[100:101], v233 offset:28672
  ds_read_b64_tr_b16 v[102:103], v233 offset:30720
  ds_read_b64_tr_b16 v[104:105], v234 offset:28672
  ds_read_b64_tr_b16 v[106:107], v234 offset:30720
  ds_read_b64_tr_b16 v[108:109], v235 offset:28672
  ds_read_b64_tr_b16 v[110:111], v235 offset:30720
  s_waitcnt lgkmcnt(8)
  v_mfma_f32_32x32x16_bf16 v[160:175], v[80:83], v[152:155], v[160:175]
  v_mfma_f32_32x32x16_bf16 v[176:191], v[84:87], v[152:155], v[176:191]
  v_mfma_f32_32x32x16_bf16 v[192:207], v[88:91], v[152:155], v[192:207]
  v_mfma_f32_32x32x16_bf16 v[208:223], v[92:95], v[152:155], v[208:223]
  s_waitcnt lgkmcnt(0)
  v_mfma_f32_32x32x16_bf16 v[160:175], v[96:99], v[156:159], v[160:175]
  v_mfma_f32_32x32x16_bf16 v[176:191], v[100:103], v[156:159], v[176:191]
  v_mfma_f32_32x32x16_bf16 v[192:207], v[104:107], v[156:159], v[192:207]
  v_mfma_f32_32x32x16_bf16 v[208:223], v[108:111], v[156:159], v[208:223]
  s_setprio 0
  s_waitcnt vmcnt(2)
  s_barrier
  v_max3_f32 v241, v112, v113, v114
  v_max3_f32 v242, v115, v116, v117
  v_max3_f32 v243, v118, v119, v120
  v_max3_f32 v244, v121, v122, v123
  v_max3_f32 v245, v124, v125, v126
  v_max3_f32 v241, v241, v242, v127
  v_max3_f32 v243, v243, v244, v245
  v_max3_f32 v242, v128, v129, v130
  v_max3_f32 v244, v131, v132, v133
  v_max3_f32 v245, v134, v135, v136
  v_max3_f32 v246, v137, v138, v139
  v_max3_f32 v247, v140, v141, v142
  v_max3_f32 v241, v241, v243, v143
  v_max3_f32 v242, v242, v244, v245
  v_max3_f32 v241, v241, v246, v247
  v_max_f32 v241, v241, v242
  v_mov_b32 v242, v241
  v_add_f32 v243, s57, v239
  s_nop 0
  v_permlane32_swap_b32 v241, v242
  v_max_f32 v241, v241, v242
  v_mul_f32 v241, s41, v241
  v_cmp_gt_f32 vcc, v241, v243
  s_nop 1
  s_cbranch_vccz L_skip_b3
  v_max_f32 v241, v239, v241
  v_sub_f32 v242, v239, v241
  v_exp_f32 v242, v242
  v_mov_b32 v239, v241
  v_mul_f32 v160, v242, v160
  v_mul_f32 v161, v242, v161
  v_mul_f32 v162, v242, v162
  v_mul_f32 v163, v242, v163
  v_mul_f32 v164, v242, v164
  v_mul_f32 v165, v242, v165
  v_mul_f32 v166, v242, v166
  v_mul_f32 v167, v242, v167
  v_mul_f32 v168, v242, v168
  v_mul_f32 v169, v242, v169
  v_mul_f32 v170, v242, v170
  v_mul_f32 v171, v242, v171
  v_mul_f32 v172, v242, v172
  v_mul_f32 v173, v242, v173
  v_mul_f32 v174, v242, v174
  v_mul_f32 v175, v242, v175
  v_mul_f32 v176, v242, v176
  v_mul_f32 v177, v242, v177
  v_mul_f32 v178, v242, v178
  v_mul_f32 v179, v242, v179
  v_mul_f32 v180, v242, v180
  v_mul_f32 v181, v242, v181
  v_mul_f32 v182, v242, v182
  v_mul_f32 v183, v242, v183
  v_mul_f32 v184, v242, v184
  v_mul_f32 v185, v242, v185
  v_mul_f32 v186, v242, v186
  v_mul_f32 v187, v242, v187
  v_mul_f32 v188, v242, v188
  v_mul_f32 v189, v242, v189
  v_mul_f32 v190, v242, v190
  v_mul_f32 v191, v242, v191
  v_mul_f32 v192, v242, v192
  v_mul_f32 v193, v242, v193
  v_mul_f32 v194, v242, v194
  v_mul_f32 v195, v242, v195
  v_mul_f32 v196, v242, v196
  v_mul_f32 v197, v242, v197
  v_mul_f32 v198, v242, v198
  v_mul_f32 v199, v242, v199
  v_mul_f32 v200, v242, v200
  v_mul_f32 v201, v242, v201
  v_mul_f32 v202, v242, v202
  v_mul_f32 v203, v242, v203
  v_mul_f32 v204, v242, v204
  v_mul_f32 v205, v242, v205
  v_mul_f32 v206, v242, v206
  v_mul_f32 v207, v242, v207
  v_mul_f32 v208, v242, v208
  v_mul_f32 v209, v242, v209
  v_mul_f32 v210, v242, v210
  v_mul_f32 v211, v242, v211
  v_mul_f32 v212, v242, v212
  v_mul_f32 v213, v242, v213
  v_mul_f32 v214, v242, v214
  v_mul_f32 v215, v242, v215
  v_mul_f32 v216, v242, v216
  v_mul_f32 v217, v242, v217
  v_mul_f32 v218, v242, v218
  v_mul_f32 v219, v242, v219
  v_mul_f32 v220, v242, v220
  v_mul_f32 v221, v242, v221
  v_mul_f32 v222, v242, v222
  v_mul_f32 v223, v242, v223
  v_mul_f32 v240, v242, v240
L_skip_b3:
  v_fma_f32 v112, v112, s41, -v239
  v_fma_f32 v113, v113, s41, -v239
  v_fma_f32 v114, v114, s41, -v239
  v_fma_f32 v115, v115, s41, -v239
  v_fma_f32 v116, v116, s41, -v239
  v_fma_f32 v117, v117, s41, -v239
  v_fma_f32 v118, v118, s41, -v239
  v_fma_f32 v119, v119, s41, -v239
  v_fma_f32 v120, v120, s41, -v239
  v_fma_f32 v121, v121, s41, -v239
  v_fma_f32 v122, v122, s41, -v239
  v_fma_f32 v123, v123, s41, -v239
  v_fma_f32 v124, v124, s41, -v239
  v_fma_f32 v125, v125, s41, -v239
  v_fma_f32 v126, v126, s41, -v239
  v_fma_f32 v127, v127, s41, -v239
  v_exp_f32 v112, v112
  v_exp_f32 v113, v113
  v_exp_f32 v114, v114
  v_exp_f32 v115, v115
  v_exp_f32 v116, v116
  v_exp_f32 v117, v117
  v_exp_f32 v118, v118
  v_exp_f32 v119, v119
  v_exp_f32 v120, v120
  v_exp_f32 v121, v121
  v_exp_f32 v122, v122
  v_exp_f32 v123, v123
  v_exp_f32 v124, v124
  v_exp_f32 v125, v125
  v_exp_f32 v126, v126
  v_exp_f32 v127, v127
  v_fma_f32 v128, v128, s41, -v239
  v_fma_f32 v129, v129, s41, -v239
  v_fma_f32 v130, v130, s41, -v239
  v_fma_f32 v131, v131, s41, -v239
  v_fma_f32 v132, v132, s41, -v239
  v_fma_f32 v133, v133, s41, -v239
  v_fma_f32 v134, v134, s41, -v239
  v_fma_f32 v135, v135, s41, -v239
  v_fma_f32 v136, v136, s41, -v239
  v_fma_f32 v137, v137, s41, -v239
  v_fma_f32 v138, v138, s41, -v239
  v_fma_f32 v139, v139, s41, -v239
  v_fma_f32 v140, v140, s41, -v239
  v_fma_f32 v141, v141, s41, -v239
  v_fma_f32 v142, v142, s41, -v239
  v_fma_f32 v143, v143, s41, -v239
  v_exp_f32 v128, v128
  v_exp_f32 v129, v129
  v_add_f32 v241, v112, v113
  v_cvt_pk_bf16_f32 v144, v112, v113
  v_add_f32 v240, v240, v241
  v_exp_f32 v130, v130
  v_exp_f32 v131, v131
  v_add_f32 v243, v114, v115
  v_cvt_pk_bf16_f32 v145, v114, v115
  v_add_f32 v240, v240, v243
  v_exp_f32 v132, v132
  v_exp_f32 v133, v133
  v_add_f32 v241, v116, v117
  v_cvt_pk_bf16_f32 v146, v116, v117
  v_add_f32 v240, v240, v241
  v_exp_f32 v134, v134
  v_exp_f32 v135, v135
  v_add_f32 v243, v118, v119
  v_cvt_pk_bf16_f32 v147, v118, v119
  v_add_f32 v240, v240, v243
  v_exp_f32 v136, v136
  v_exp_f32 v137, v137
  v_add_f32 v241, v120, v121
  v_cvt_pk_bf16_f32 v148, v120, v121
  v_add_f32 v240, v240, v241
  v_exp_f32 v138, v138
  v_exp_f32 v139, v139
  v_add_f32 v243, v122, v123
  v_cvt_pk_bf16_f32 v149, v122, v123
  v_add_f32 v240, v240, v243
  v_exp_f32 v140, v140
  v_exp_f32 v141, v141
  v_add_f32 v241, v124, v125
  v_cvt_pk_bf16_f32 v150, v124, v125
  v_add_f32 v240, v240, v241
  v_exp_f32 v142, v142
  v_exp_f32 v143, v143
  v_add_f32 v243, v126, v127
  v_cvt_pk_bf16_f32 v151, v126, v127
  v_add_f32 v240, v240, v243
  v_add_f32 v241, v128, v129
  v_cvt_pk_bf16_f32 v152, v128, v129
  v_add_f32 v240, v240, v241
  v_add_f32 v243, v130, v131
  v_cvt_pk_bf16_f32 v153, v130, v131
  v_add_f32 v240, v240, v243
  v_add_f32 v241, v132, v133
  v_cvt_pk_bf16_f32 v154, v132, v133
  v_add_f32 v240, v240, v241
  v_add_f32 v243, v134, v135
  v_cvt_pk_bf16_f32 v155, v134, v135
  v_add_f32 v240, v240, v243
  v_add_f32 v241, v136, v137
  v_cvt_pk_bf16_f32 v156, v136, v137
  v_add_f32 v240, v240, v241
  v_add_f32 v243, v138, v139
  v_cvt_pk_bf16_f32 v157, v138, v139
  v_add_f32 v240, v240, v243
  v_add_f32 v241, v140, v141
  v_cvt_pk_bf16_f32 v158, v140, v141
  v_add_f32 v240, v240, v241
  v_add_f32 v243, v142, v143
  v_cvt_pk_bf16_f32 v159, v142, v143
  v_add_f32 v240, v240, v243
  s_waitcnt vmcnt(0)
  s_barrier
  s_setprio 1
  ds_read_b64_tr_b16 v[80:81], v232 offset:49152
  ds_read_b64_tr_b16 v[82:83], v232 offset:51200
  ds_read_b64_tr_b16 v[84:85], v233 offset:49152
  ds_read_b64_tr_b16 v[86:87], v233 offset:51200
  ds_read_b64_tr_b16 v[88:89], v234 offset:49152
  ds_read_b64_tr_b16 v[90:91], v234 offset:51200
  ds_read_b64_tr_b16 v[92:93], v235 offset:49152
  ds_read_b64_tr_b16 v[94:95], v235 offset:51200
  ds_read_b64_tr_b16 v[96:97], v232 offset:53248
  ds_read_b64_tr_b16 v[98:99], v232 offset:55296
  ds_read_b64_tr_b16 v[100:101], v233 offset:53248
  ds_read_b64_tr_b16 v[102:103], v233 offset:55296
  ds_read_b64_tr_b16 v[104:105], v234 offset:53248
  ds_read_b64_tr_b16 v[106:107], v234 offset:55296
  ds_read_b64_tr_b16 v[108:109], v235 offset:53248
  ds_read_b64_tr_b16 v[110:111], v235 offset:55296
  s_waitcnt lgkmcnt(8)
  v_mfma_f32_32x32x16_bf16 v[160:175], v[80:83], v[144:147], v[160:175]
  v_mfma_f32_32x32x16_bf16 v[176:191], v[84:87], v[144:147], v[176:191]
  v_mfma_f32_32x32x16_bf16 v[192:207], v[88:91], v[144:147], v[192:207]
  v_mfma_f32_32x32x16_bf16 v[208:223], v[92:95], v[144:147], v[208:223]
  ds_read_b64_tr_b16 v[80:81], v232 offset:57344
  ds_read_b64_tr_b16 v[82:83], v232 offset:59392
  ds_read_b64_tr_b16 v[84:85], v233 offset:57344
  ds_read_b64_tr_b16 v[86:87], v233 offset:59392
  ds_read_b64_tr_b16 v[88:89], v234 offset:57344
  ds_read_b64_tr_b16 v[90:91], v234 offset:59392
  ds_read_b64_tr_b16 v[92:93], v235 offset:57344
  ds_read_b64_tr_b16 v[94:95], v235 offset:59392
  s_waitcnt lgkmcnt(8)
  v_mfma_f32_32x32x16_bf16 v[160:175], v[96:99], v[148:151], v[160:175]
  v_mfma_f32_32x32x16_bf16 v[176:191], v[100:103], v[148:151], v[176:191]
  v_mfma_f32_32x32x16_bf16 v[192:207], v[104:107], v[148:151], v[192:207]
  v_mfma_f32_32x32x16_bf16 v[208:223], v[108:111], v[148:151], v[208:223]
  ds_read_b64_tr_b16 v[96:97], v232 offset:61440
  ds_read_b64_tr_b16 v[98:99], v232 offset:63488
  ds_read_b64_tr_b16 v[100:101], v233 offset:61440
  ds_read_b64_tr_b16 v[102:103], v233 offset:63488
  ds_read_b64_tr_b16 v[104:105], v234 offset:61440
  ds_read_b64_tr_b16 v[106:107], v234 offset:63488
  ds_read_b64_tr_b16 v[108:109], v235 offset:61440
  ds_read_b64_tr_b16 v[110:111], v235 offset:63488
  s_waitcnt lgkmcnt(8)
  v_mfma_f32_32x32x16_bf16 v[160:175], v[80:83], v[152:155], v[160:175]
  v_mfma_f32_32x32x16_bf16 v[176:191], v[84:87], v[152:155], v[176:191]
  v_mfma_f32_32x32x16_bf16 v[192:207], v[88:91], v[152:155], v[192:207]
  v_mfma_f32_32x32x16_bf16 v[208:223], v[92:95], v[152:155], v[208:223]
  s_waitcnt lgkmcnt(0)
  v_mfma_f32_32x32x16_bf16 v[160:175], v[96:99], v[156:159], v[160:175]
  v_mfma_f32_32x32x16_bf16 v[176:191], v[100:103], v[156:159], v[176:191]
  v_mfma_f32_32x32x16_bf16 v[192:207], v[104:107], v[156:159], v[192:207]
  v_mfma_f32_32x32x16_bf16 v[208:223], v[108:111], v[156:159], v[208:223]
  s_setprio 0
L_epi:
  s_cmp_lg_u32 s20, 0
  s_cbranch_scc1 L_nard
  buffer_load_dword v104, v15, s[60:63], 0 offen sc1
L_nard:
  v_mov_b32 v242, v240
  s_nop 7
  s_nop 7
  v_permlane32_swap_b32 v240, v242
  v_add_f32 v240, v240, v242
  s_barrier
  s_lshl_b32 s43, s20, 14
  v_lshlrev_b32 v8, 4, v2
  v_add_u32 v9, s43, v8
  ds_write_b128 v9, v[160:163] offset:0
  ds_write_b128 v9, v[164:167] offset:1024
  ds_write_b128 v9, v[168:171] offset:2048
  ds_write_b128 v9, v[172:175] offset:3072
  ds_write_b128 v9, v[176:179] offset:4096
  ds_write_b128 v9, v[180:183] offset:5120
  ds_write_b128 v9, v[184:187] offset:6144
  ds_write_b128 v9, v[188:191] offset:7168
  ds_write_b128 v9, v[192:195] offset:8192
  ds_write_b128 v9, v[196:199] offset:9216
  ds_write_b128 v9, v[200:203] offset:10240
  ds_write_b128 v9, v[204:207] offset:11264
  ds_write_b128 v9, v[208:211] offset:12288
  ds_write_b128 v9, v[212:215] offset:13312
  ds_write_b128 v9, v[216:219] offset:14336
  ds_write_b128 v9, v[220:223] offset:15360
  s_lshl_b32 s43, s20, 9
  v_lshlrev_b32 v10, 3, v2
  v_add_u32 v11, s43, v10
  v_add_u32 v11, 131136, v11
  v_mov_b32 v12, v239
  v_mov_b32 v13, v240
  ds_write_b64 v11, v[12:13]
  s_cmp_lg_u32 s20, 0
  s_cbranch_scc1 L_nard2
  s_waitcnt vmcnt(0)
  v_readfirstlane_b32 s46, v104
  s_nop 3
  s_lshr_b32 s46, s46, s65
  s_and_b32 s46, s46, 0xff
  s_cmp_lg_u32 s46, 4
  s_cselect_b32 s47, 2, 1
  v_mov_b32 v105, 131072
  v_mov_b32 v106, s47
  ds_write_b32 v105, v106
L_nard2:
  s_waitcnt lgkmcnt(0)
  s_barrier
  v_mov_b32 v105, 131072
  ds_read_b32 v106, v105
  s_lshl_b32 s43, s20, 11
  v_add_u32 v9, s43, v8
  v_add_u32 v10, 131136, v10
  s_lshl_b32 s46, s2, 15
  s_add_u32 s48, s10, s46
  s_addc_u32 s49, s11, 0
  s_mov_b32 s50, 32768
  s_mov_b32 s51, 0x00020000
  s_lshl_b32 s40, s20, 10
  s_waitcnt lgkmcnt(0)
  v_readfirstlane_b32 s47, v106
  ds_read_b64 v[80:81], v10 offset:0
  ds_read_b64 v[82:83], v10 offset:2048
  v_add_u32 v14, 0, v9
  ds_read_b128 v[16:19], v14
  ds_read_b128 v[20:23], v14 offset:1024
  v_add_u32 v14, 65536, v9
  ds_read_b128 v[24:27], v14
  ds_read_b128 v[28:31], v14 offset:1024
  ds_read_b64 v[84:85], v10 offset:512
  ds_read_b64 v[86:87], v10 offset:2560
  v_add_u32 v14, 16384, v9
  ds_read_b128 v[32:35], v14
  ds_read_b128 v[36:39], v14 offset:1024
  v_add_u32 v14, 81920, v9
  ds_read_b128 v[40:43], v14
  ds_read_b128 v[44:47], v14 offset:1024
  s_waitcnt lgkmcnt(6)
  ds_read_b64 v[88:89], v10 offset:1024
  ds_read_b64 v[90:91], v10 offset:3072
  v_add_u32 v14, 32768, v9
  ds_read_b128 v[48:51], v14
  ds_read_b128 v[52:55], v14 offset:1024
  v_add_u32 v14, 98304, v9
  ds_read_b128 v[56:59], v14
  ds_read_b128 v[60:63], v14 offset:1024
  v_max_f32 v100, v80, v82
  v_sub_f32 v101, v80, v100
  v_sub_f32 v102, v82, v100
  v_exp_f32 v101, v101
  v_exp_f32 v102, v102
  s_nop 0
  v_mul_f32 v103, v101, v81
  v_fma_f32 v81, v102, v83, v103
  v_mov_b32 v80, v100
  v_mul_f32 v16, v101, v16
  v_fma_f32 v16, v102, v24, v16
  v_mul_f32 v17, v101, v17
  v_fma_f32 v17, v102, v25, v17
  v_mul_f32 v18, v101, v18
  v_fma_f32 v18, v102, v26, v18
  v_mul_f32 v19, v101, v19
  v_fma_f32 v19, v102, v27, v19
  v_mul_f32 v20, v101, v20
  v_fma_f32 v20, v102, v28, v20
  v_mul_f32 v21, v101, v21
  v_fma_f32 v21, v102, v29, v21
  v_mul_f32 v22, v101, v22
  v_fma_f32 v22, v102, v30, v22
  v_mul_f32 v23, v101, v23
  v_fma_f32 v23, v102, v31, v23
  v_cvt_pk_bf16_f32 v24, v16, v17
  v_cvt_pk_bf16_f32 v25, v18, v19
  v_cvt_pk_bf16_f32 v26, v20, v21
  v_cvt_pk_bf16_f32 v27, v22, v23
  s_cmp_lg_u32 s59, 0
  s_cbranch_scc1 L_st0
  v_mov_b32 v108, v16
  v_mov_b32 v109, v17
  v_mov_b32 v110, v18
  v_mov_b32 v111, v19
  v_mov_b32 v112, v20
  v_mov_b32 v113, v21
  v_mov_b32 v114, v22
  v_mov_b32 v115, v23
  v_mov_b32 v116, v80
  v_mov_b32 v117, v81
  s_cmp_eq_u32 s47, 1
  s_cbranch_scc1 L_nost0
L_st0:
  s_add_u32 s46, s40, 0
  buffer_store_dwordx4 v[24:27], v8, s[48:51], s46 offen sc1
L_nost0:
  s_waitcnt lgkmcnt(6)
  ds_read_b64 v[92:93], v10 offset:1536
  ds_read_b64 v[94:95], v10 offset:3584
  v_add_u32 v14, 49152, v9
  ds_read_b128 v[64:67], v14
  ds_read_b128 v[68:71], v14 offset:1024
  v_add_u32 v14, 114688, v9
  ds_read_b128 v[72:75], v14
  ds_read_b128 v[76:79], v14 offset:1024
  v_max_f32 v100, v84, v86
  v_sub_f32 v101, v84, v100
  v_sub_f32 v102, v86, v100
  v_exp_f32 v101, v101
  v_exp_f32 v102, v102
  s_nop 0
  v_mul_f32 v103, v101, v85
  v_fma_f32 v85, v102, v87, v103
  v_mov_b32 v84, v100
  v_mul_f32 v32, v101, v32
  v_fma_f32 v32, v102, v40, v32
  v_mul_f32 v33, v101, v33
  v_fma_f32 v33, v102, v41, v33
  v_mul_f32 v34, v101, v34
  v_fma_f32 v34, v102, v42, v34
  v_mul_f32 v35, v101, v35
  v_fma_f32 v35, v102, v43, v35
  v_mul_f32 v36, v101, v36
  v_fma_f32 v36, v102, v44, v36
  v_mul_f32 v37, v101, v37
  v_fma_f32 v37, v102, v45, v37
  v_mul_f32 v38, v101, v38
  v_fma_f32 v38, v102, v46, v38
  v_mul_f32 v39, v101, v39
  v_fma_f32 v39, v102, v47, v39
  v_cvt_pk_bf16_f32 v40, v32, v33
  v_cvt_pk_bf16_f32 v41, v34, v35
  v_cvt_pk_bf16_f32 v42, v36, v37
  v_cvt_pk_bf16_f32 v43, v38, v39
  s_cmp_lg_u32 s59, 1
  s_cbranch_scc1 L_st1
  v_mov_b32 v108, v32
  v_mov_b32 v109, v33
  v_mov_b32 v110, v34
  v_mov_b32 v111, v35
  v_mov_b32 v112, v36
  v_mov_b32 v113, v37
  v_mov_b32 v114, v38
  v_mov_b32 v115, v39
  v_mov_b32 v116, v84
  v_mov_b32 v117, v85
  s_cmp_eq_u32 s47, 1
  s_cbranch_scc1 L_nost1
L_st1:
  s_add_u32 s46, s40, 8192
  buffer_store_dwordx4 v[40:43], v8, s[48:51], s46 offen sc1
L_nost1:
  s_waitcnt lgkmcnt(6)
  v_max_f32 v100, v88, v90
  v_sub_f32 v101, v88, v100
  v_sub_f32 v102, v90, v100
  v_exp_f32 v101, v101
  v_exp_f32 v102, v102
  s_nop 0
  v_mul_f32 v103, v101, v89
  v_fma_f32 v89, v102, v91, v103
  v_mov_b32 v88, v100
  v_mul_f32 v48, v101, v48
  v_fma_f32 v48, v102, v56, v48
  v_mul_f32 v49, v101, v49
  v_fma_f32 v49, v102, v57, v49
  v_mul_f32 v50, v101, v50
  v_fma_f32 v50, v102, v58, v50
  v_mul_f32 v51, v101, v51
  v_fma_f32 v51, v102, v59, v51
  v_mul_f32 v52, v101, v52
  v_fma_f32 v52, v102, v60, v52
  v_mul_f32 v53, v101, v53
  v_fma_f32 v53, v102, v61, v53
  v_mul_f32 v54, v101, v54
  v_fma_f32 v54, v102, v62, v54
  v_mul_f32 v55, v101, v55
  v_fma_f32 v55, v102, v63, v55
  v_cvt_pk_bf16_f32 v56, v48, v49
  v_cvt_pk_bf16_f32 v57, v50, v51
  v_cvt_pk_bf16_f32 v58, v52, v53
  v_cvt_pk_bf16_f32 v59, v54, v55
  s_cmp_lg_u32 s59, 2
  s_cbranch_scc1 L_st2
  v_mov_b32 v108, v48
  v_mov_b32 v109, v49
  v_mov_b32 v110, v50
  v_mov_b32 v111, v51
  v_mov_b32 v112, v52
  v_mov_b32 v113, v53
  v_mov_b32 v114, v54
  v_mov_b32 v115, v55
  v_mov_b32 v116, v88
  v_mov_b32 v117, v89
  s_cmp_eq_u32 s47, 1
  s_cbranch_scc1 L_nost2
L_st2:
  s_add_u32 s46, s40, 16384
  buffer_store_dwordx4 v[56:59], v8, s[48:51], s46 offen sc1
L_nost2:
  s_waitcnt lgkmcnt(0)
  v_max_f32 v100, v92, v94
  v_sub_f32 v101, v92, v100
  v_sub_f32 v102, v94, v100
  v_exp_f32 v101, v101
  v_exp_f32 v102, v102
  s_nop 0
  v_mul_f32 v103, v101, v93
  v_fma_f32 v93, v102, v95, v103
  v_mov_b32 v92, v100
  v_mul_f32 v64, v101, v64
  v_fma_f32 v64, v102, v72, v64
  v_mul_f32 v65, v101, v65
  v_fma_f32 v65, v102, v73, v65
  v_mul_f32 v66, v101, v66
  v_fma_f32 v66, v102, v74, v66
  v_mul_f32 v67, v101, v67
  v_fma_f32 v67, v102, v75, v67
  v_mul_f32 v68, v101, v68
  v_fma_f32 v68, v102, v76, v68
  v_mul_f32 v69, v101, v69
  v_fma_f32 v69, v102, v77, v69
  v_mul_f32 v70, v101, v70
  v_fma_f32 v70, v102, v78, v70
  v_mul_f32 v71, v101, v71
  v_fma_f32 v71, v102, v79, v71
  v_cvt_pk_bf16_f32 v72, v64, v65
  v_cvt_pk_bf16_f32 v73, v66, v67
  v_cvt_pk_bf16_f32 v74, v68, v69
  v_cvt_pk_bf16_f32 v75, v70, v71
  s_cmp_lg_u32 s59, 3
  s_cbranch_scc1 L_st3
  v_mov_b32 v108, v64
  v_mov_b32 v109, v65
  v_mov_b32 v110, v66
  v_mov_b32 v111, v67
  v_mov_b32 v112, v68
  v_mov_b32 v113, v69
  v_mov_b32 v114, v70
  v_mov_b32 v115, v71
  v_mov_b32 v116, v92
  v_mov_b32 v117, v93
  s_cmp_eq_u32 s47, 1
  s_cbranch_scc1 L_nost3
L_st3:
  s_add_u32 s46, s40, 24576
  buffer_store_dwordx4 v[72:75], v8, s[48:51], s46 offen sc1
L_nost3:
  s_cmp_lg_u32 s20, 0
  s_cbranch_scc1 L_noml
  s_lshl_b32 s46, s2, 10
  s_add_u32 s46, s46, 16777216
  s_add_u32 s52, s10, s46
  s_addc_u32 s53, s11, 0
  v_lshlrev_b32 v14, 3, v2
  s_mov_b32 s55, 0x00020000
  s_mov_b32 s54, 1024
  v_cmp_gt_u32 vcc, 32, v2
  s_and_saveexec_b64 s[44:45], vcc
  buffer_store_dwordx2 v[80:81], v14, s[52:55], 0 offen offset:0 sc1
  buffer_store_dwordx2 v[84:85], v14, s[52:55], 0 offen offset:256 sc1
  buffer_store_dwordx2 v[88:89], v14, s[52:55], 0 offen offset:512 sc1
  buffer_store_dwordx2 v[92:93], v14, s[52:55], 0 offen offset:768 sc1
  s_mov_b64 exec, s[44:45]
L_noml:
  s_waitcnt vmcnt(0)
  s_barrier
  s_cmp_lg_u32 s20, 0
  s_cbranch_scc1 L_w_notzero
  v_mov_b32 v104, s47
  buffer_store_dword v104, v15, s[16:19], 0 offen sc1
  s_cmp_eq_u32 s47, 2
  s_cbranch_scc1 L_w_notzero
  s_lshl_b32 s24, s58, 9
  s_add_u32 s24, s24, 17825792
  s_add_u32 s16, s10, s24
  s_addc_u32 s17, s11, 0
  s_mov_b32 s18, 512
  v_lshlrev_b32 v105, 7, v2
L_poll:
  buffer_load_dword v104, v105, s[16:19], 0 offen sc1
  s_waitcnt vmcnt(0)
  v_readlane_b32 s24, v104, 0
  v_readlane_b32 s25, v104, 1
  v_readlane_b32 s26, v104, 2
  v_readlane_b32 s27, v104, 3
  s_nop 3
  s_min_u32 s44, s24, s25
  s_min_u32 s45, s26, s27
  s_min_u32 s44, s44, s45
  s_cmp_eq_u32 s44, 0
  s_cbranch_scc0 L_polldone
  s_sleep 1
  s_branch L_poll
L_polldone:
  s_mov_b32 s44, 0
  s_mov_b32 s45, 0
  s_cmp_eq_u32 s24, 2
  s_cselect_b32 s46, 1, 0
  s_cselect_b32 s42, 0, 1
  s_or_b32 s44, s44, s46
  s_or_b32 s45, s45, s42
  s_cmp_eq_u32 s25, 2
  s_cselect_b32 s46, 2, 0
  s_cselect_b32 s42, 0, 2
  s_or_b32 s44, s44, s46
  s_or_b32 s45, s45, s42
  s_cmp_eq_u32 s26, 2
  s_cselect_b32 s46, 4, 0
  s_cselect_b32 s42, 0, 4
  s_or_b32 s44, s44, s46
  s_or_b32 s45, s45, s42
  s_cmp_eq_u32 s27, 2
  s_cselect_b32 s46, 8, 0
  s_cselect_b32 s42, 0, 8
  s_or_b32 s44, s44, s46
  s_or_b32 s45, s45, s42
  s_ff1_i32_b32 s46, s45
  s_cmp_eq_u32 s46, s59
  s_cselect_b32 s42, s44, 0
  v_mov_b32 v105, 131076
  v_mov_b32 v106, s42
  ds_write_b32 v105, v106
  s_waitcnt lgkmcnt(0)
L_w_notzero:
  s_barrier
  s_cmp_eq_u32 s47, 2
  s_cbranch_scc1 L_done
  s_lshl_b32 s46, s58, 17
  s_add_u32 s48, s10, s46
  s_addc_u32 s49, s11, 0
  s_mov_b32 s50, 131072
  s_lshl_b32 s46, s58, 12
  s_add_u32 s46, s46, 16777216
  s_add_u32 s52, s10, s46
  s_addc_u32 s53, s11, 0
  s_mov_b32 s54, 4096
  s_mov_b32 s55, 0x00020000
  v_and_b32 v20, 31, v2
  v_lshlrev_b32 v20, 3, v20
  s_lshl_b32 s44, s59, 8
  s_lshl_b32 s45, s59, 13
  s_add_u32 s45, s45, s40
  s_add_u32 s46, s59, 1
  s_and_b32 s46, s46, 3
  s_lshl_b32 s24, s46, 10
  s_add_u32 s24, s24, s44
  buffer_load_dwordx2 v[24:25], v20, s[52:55], s24 offen sc1
  s_lshl_b32 s24, s46, 15
  s_add_u32 s24, s24, s45
  buffer_load_dwordx4 v[32:35], v8, s[48:51], s24 offen sc1
  s_add_u32 s46, s59, 2
  s_and_b32 s46, s46, 3
  s_lshl_b32 s24, s46, 10
  s_add_u32 s24, s24, s44
  buffer_load_dwordx2 v[26:27], v20, s[52:55], s24 offen sc1
  s_lshl_b32 s24, s46, 15
  s_add_u32 s24, s24, s45
  buffer_load_dwordx4 v[36:39], v8, s[48:51], s24 offen sc1
  s_add_u32 s46, s59, 3
  s_and_b32 s46, s46, 3
  s_lshl_b32 s24, s46, 10
  s_add_u32 s24, s24, s44
  buffer_load_dwordx2 v[28:29], v20, s[52:55], s24 offen sc1
  s_lshl_b32 s24, s46, 15
  s_add_u32 s24, s24, s45
  buffer_load_dwordx4 v[40:43], v8, s[48:51], s24 offen sc1
  v_mov_b32 v105, 131076
  ds_read_b32 v106, v105
  v_lshrrev_b32 v6, 5, v2
  v_and_b32 v7, 31, v2
  v_lshlrev_b32 v7, 8, v7
  v_lshl_add_u32 v7, v6, 4, v7
  s_lshl_b32 s46, s20, 5
  v_add_u32 v7, s46, v7
  s_mov_b32 s61, 0xffff0000
  s_waitcnt lgkmcnt(0)
  v_readfirstlane_b32 s42, v106
  s_waitcnt vmcnt(0)
  v_max_f32 v16, v116, v24
  v_max3_f32 v16, v16, v26, v28
  v_sub_f32 v116, v116, v16
  v_sub_f32 v24, v24, v16
  v_sub_f32 v26, v26, v16
  v_sub_f32 v28, v28, v16
  v_exp_f32 v116, v116
  v_exp_f32 v24, v24
  v_exp_f32 v26, v26
  v_exp_f32 v28, v28
  s_nop 0
  v_mul_f32 v17, v116, v117
  v_fma_f32 v17, v24, v25, v17
  v_fma_f32 v17, v26, v27, v17
  v_fma_f32 v17, v28, v29, v17
  v_rcp_f32 v17, v17
  s_nop 0
  v_mul_f32 v116, v116, v17
  v_mul_f32 v24, v24, v17
  v_mul_f32 v26, v26, v17
  v_mul_f32 v28, v28, v17
  v_mul_f32 v108, v116, v108
  v_mul_f32 v109, v116, v109
  v_mul_f32 v110, v116, v110
  v_mul_f32 v111, v116, v111
  v_mul_f32 v112, v116, v112
  v_mul_f32 v113, v116, v113
  v_mul_f32 v114, v116, v114
  v_mul_f32 v115, v116, v115
  v_lshlrev_b32 v18, 16, v32
  v_and_b32 v19, s61, v32
  v_fma_f32 v108, v24, v18, v108
  v_fma_f32 v109, v24, v19, v109
  v_lshlrev_b32 v18, 16, v33
  v_and_b32 v19, s61, v33
  v_fma_f32 v110, v24, v18, v110
  v_fma_f32 v111, v24, v19, v111
  v_lshlrev_b32 v18, 16, v34
  v_and_b32 v19, s61, v34
  v_fma_f32 v112, v24, v18, v112
  v_fma_f32 v113, v24, v19, v113
  v_lshlrev_b32 v18, 16, v35
  v_and_b32 v19, s61, v35
  v_fma_f32 v114, v24, v18, v114
  v_fma_f32 v115, v24, v19, v115
  v_lshlrev_b32 v18, 16, v36
  v_and_b32 v19, s61, v36
  v_fma_f32 v108, v26, v18, v108
  v_fma_f32 v109, v26, v19, v109
  v_lshlrev_b32 v18, 16, v37
  v_and_b32 v19, s61, v37
  v_fma_f32 v110, v26, v18, v110
  v_fma_f32 v111, v26, v19, v111
  v_lshlrev_b32 v18, 16, v38
  v_and_b32 v19, s61, v38
  v_fma_f32 v112, v26, v18, v112
  v_fma_f32 v113, v26, v19, v113
  v_lshlrev_b32 v18, 16, v39
  v_and_b32 v19, s61, v39
  v_fma_f32 v114, v26, v18, v114
  v_fma_f32 v115, v26, v19, v115
  v_lshlrev_b32 v18, 16, v40
  v_and_b32 v19, s61, v40
  v_fma_f32 v108, v28, v18, v108
  v_fma_f32 v109, v28, v19, v109
  v_lshlrev_b32 v18, 16, v41
  v_and_b32 v19, s61, v41
  v_fma_f32 v110, v28, v18, v110
  v_fma_f32 v111, v28, v19, v111
  v_lshlrev_b32 v18, 16, v42
  v_and_b32 v19, s61, v42
  v_fma_f32 v112, v28, v18, v112
  v_fma_f32 v113, v28, v19, v113
  v_lshlrev_b32 v18, 16, v43
  v_and_b32 v19, s61, v43
  v_fma_f32 v114, v28, v18, v114
  v_fma_f32 v115, v28, v19, v115
  v_cvt_pk_bf16_f32 v64, v108, v109
  v_cvt_pk_bf16_f32 v65, v110, v111
  v_cvt_pk_bf16_f32 v66, v112, v113
  v_cvt_pk_bf16_f32 v67, v114, v115
  s_nop 1
  v_permlane32_swap_b32 v64, v66
  v_permlane32_swap_b32 v65, v67
  s_lshl_b32 s46, s58, 2
  s_add_u32 s46, s46, s59
  s_lshl_b32 s46, s46, 13
  s_add_u32 s28, s12, s46
  s_addc_u32 s29, s13, 0
  s_mov_b32 s30, 8192
  s_mov_b32 s31, 0x00020000
  buffer_store_dwordx4 v[64:67], v7, s[28:31], 0 offen
L_finloop:
  s_cmp_eq_u32 s42, 0
  s_cbranch_scc1 L_finend
  s_ff1_i32_b32 s44, s42
  s_lshl_b32 s45, 1, s44
  s_andn2_b32 s42, s42, s45
  s_lshl_b32 s45, s44, 8
  buffer_load_dwordx2 v[24:25], v20, s[52:55], s45 offen offset:0 sc1
  buffer_load_dwordx2 v[26:27], v20, s[52:55], s45 offen offset:1024 sc1
  buffer_load_dwordx2 v[28:29], v20, s[52:55], s45 offen offset:2048 sc1
  buffer_load_dwordx2 v[30:31], v20, s[52:55], s45 offen offset:3072 sc1
  s_lshl_b32 s45, s44, 13
  s_add_u32 s45, s45, s40
  buffer_load_dwordx4 v[32:35], v8, s[48:51], s45 offen sc1
  s_add_u32 s45, s45, 32768
  buffer_load_dwordx4 v[36:39], v8, s[48:51], s45 offen sc1
  s_add_u32 s45, s45, 32768
  buffer_load_dwordx4 v[40:43], v8, s[48:51], s45 offen sc1
  s_add_u32 s45, s45, 32768
  buffer_load_dwordx4 v[44:47], v8, s[48:51], s45 offen sc1
  s_waitcnt vmcnt(0)
  v_max_f32 v16, v24, v26
  v_max3_f32 v16, v16, v28, v30
  v_sub_f32 v24, v24, v16
  v_sub_f32 v26, v26, v16
  v_sub_f32 v28, v28, v16
  v_sub_f32 v30, v30, v16
  v_exp_f32 v24, v24
  v_exp_f32 v26, v26
  v_exp_f32 v28, v28
  v_exp_f32 v30, v30
  s_nop 0
  v_mul_f32 v17, v24, v25
  v_fma_f32 v17, v26, v27, v17
  v_fma_f32 v17, v28, v29, v17
  v_fma_f32 v17, v30, v31, v17
  v_rcp_f32 v17, v17
  s_nop 0
  v_mul_f32 v24, v24, v17
  v_mul_f32 v26, v26, v17
  v_mul_f32 v28, v28, v17
  v_mul_f32 v30, v30, v17
  v_lshlrev_b32 v18, 16, v32
  v_and_b32 v19, s61, v32
  v_mul_f32 v108, v24, v18
  v_mul_f32 v109, v24, v19
  v_lshlrev_b32 v18, 16, v33
  v_and_b32 v19, s61, v33
  v_mul_f32 v110, v24, v18
  v_mul_f32 v111, v24, v19
  v_lshlrev_b32 v18, 16, v34
  v_and_b32 v19, s61, v34
  v_mul_f32 v112, v24, v18
  v_mul_f32 v113, v24, v19
  v_lshlrev_b32 v18, 16, v35
  v_and_b32 v19, s61, v35
  v_mul_f32 v114, v24, v18
  v_mul_f32 v115, v24, v19
  v_lshlrev_b32 v18, 16, v36
  v_and_b32 v19, s61, v36
  v_fma_f32 v108, v26, v18, v108
  v_fma_f32 v109, v26, v19, v109
  v_lshlrev_b32 v18, 16, v37
  v_and_b32 v19, s61, v37
  v_fma_f32 v110, v26, v18, v110
  v_fma_f32 v111, v26, v19, v111
  v_lshlrev_b32 v18, 16, v38
  v_and_b32 v19, s61, v38
  v_fma_f32 v112, v26, v18, v112
  v_fma_f32 v113, v26, v19, v113
  v_lshlrev_b32 v18, 16, v39
  v_and_b32 v19, s61, v39
  v_fma_f32 v114, v26, v18, v114
  v_fma_f32 v115, v26, v19, v115
  v_lshlrev_b32 v18, 16, v40
  v_and_b32 v19, s61, v40
  v_fma_f32 v108, v28, v18, v108
  v_fma_f32 v109, v28, v19, v109
  v_lshlrev_b32 v18, 16, v41
  v_and_b32 v19, s61, v41
  v_fma_f32 v110, v28, v18, v110
  v_fma_f32 v111, v28, v19, v111
  v_lshlrev_b32 v18, 16, v42
  v_and_b32 v19, s61, v42
  v_fma_f32 v112, v28, v18, v112
  v_fma_f32 v113, v28, v19, v113
  v_lshlrev_b32 v18, 16, v43
  v_and_b32 v19, s61, v43
  v_fma_f32 v114, v28, v18, v114
  v_fma_f32 v115, v28, v19, v115
  v_lshlrev_b32 v18, 16, v44
  v_and_b32 v19, s61, v44
  v_fma_f32 v108, v30, v18, v108
  v_fma_f32 v109, v30, v19, v109
  v_lshlrev_b32 v18, 16, v45
  v_and_b32 v19, s61, v45
  v_fma_f32 v110, v30, v18, v110
  v_fma_f32 v111, v30, v19, v111
  v_lshlrev_b32 v18, 16, v46
  v_and_b32 v19, s61, v46
  v_fma_f32 v112, v30, v18, v112
  v_fma_f32 v113, v30, v19, v113
  v_lshlrev_b32 v18, 16, v47
  v_and_b32 v19, s61, v47
  v_fma_f32 v114, v30, v18, v114
  v_fma_f32 v115, v30, v19, v115
  v_cvt_pk_bf16_f32 v64, v108, v109
  v_cvt_pk_bf16_f32 v65, v110, v111
  v_cvt_pk_bf16_f32 v66, v112, v113
  v_cvt_pk_bf16_f32 v67, v114, v115
  s_nop 1
  v_permlane32_swap_b32 v64, v66
  v_permlane32_swap_b32 v65, v67
  s_lshl_b32 s46, s58, 2
  s_add_u32 s46, s46, s44
  s_lshl_b32 s46, s46, 13
  s_add_u32 s28, s12, s46
  s_addc_u32 s29, s13, 0
  s_mov_b32 s30, 8192
  s_mov_b32 s31, 0x00020000
  buffer_store_dwordx4 v[64:67], v7, s[28:31], 0 offen
  s_branch L_finloop
L_finend:
L_done:
  s_endpgm
.section .rodata,"a"
.p2align 6
.amdhsa_kernel standalone__gqa_softmax__sampling_kernel
  .amdhsa_next_free_vgpr 256
  .amdhsa_next_free_sgpr 72
  .amdhsa_accum_offset 256
  .amdhsa_group_segment_fixed_size 0
  .amdhsa_kernarg_size 48
  .amdhsa_user_sgpr_count 2
  .amdhsa_user_sgpr_kernarg_segment_ptr 1
  .amdhsa_system_sgpr_workgroup_id_x 1
.end_amdhsa_kernel
```
